```python
import torch

def _softmax(x, axis=-1):
    return torch.softmax(x, dim=axis)
def _gelu(x):
    return torch.nn.functional.gelu(x, approximate="tanh")
def _silu(x):
    return torch.nn.functional.silu(x)
def _sigmoid(x):
    return torch.sigmoid(x)
def _layernorm(x, axis=-1, eps=1e-5):
    m = x.mean(dim=axis, keepdim=True)
    v = x.var(dim=axis, keepdim=True, unbiased=False)
    return (x - m) / torch.sqrt(v + eps)
def _scatter_add(tgt, idx, src, axis=0):
    return tgt.clone().index_add_(axis, idx, src)
def _segment_sum(src, seg, n):
    out = torch.zeros((n,) + src.shape[1:], dtype=src.dtype)
    return out.index_add_(0, seg, src)
def _pad(x, pw):
    flat = tuple(v for pair in reversed(pw) for v in pair)
    return torch.nn.functional.pad(x, flat)

kernel_name = 'recurrent_scan__gqa_block_cached__glu_gated_geglu__decode'

def setup_inputs():

    _w = (lambda a: (lambda t: t.to(torch.bfloat16) if t.is_floating_point() else t)(torch.as_tensor(a)))
    def _A_setup():
        B, Sq, D = 4, 1, 1024
        Hq, Hkv, Sk, Dh = 32, 4, 8192, 128
        assert Hq % Hkv == 0, (Hq, Hkv)
        return {
            "x": _w((lambda *s: torch.randn(*s, dtype=torch.bfloat16) * 0.4)(B, Sq, D)),
            "k_cache": _w((lambda *s: torch.randn(*s, dtype=torch.bfloat16) * 1.6)(B, Hkv, Sk, Dh)),
            "v_cache": _w((lambda *s: torch.randn(*s, dtype=torch.bfloat16) * 1.6)(B, Hkv, Sk, Dh)),
            "wq": _w((lambda *s: torch.randn(*s, dtype=torch.bfloat16) * 1.6)(D, Hq * Dh) * (D ** -0.5)),
            "wo": _w((lambda *s: torch.randn(*s, dtype=torch.bfloat16) * 1.6)(Hq * Dh, D) * ((Hq * Dh) ** -0.5)),
        }
    _A_in = _A_setup()

    def _B_setup():
        B, S, Dm, Df = 4, 1, 1024, 3584
        return {
            "x": _w((lambda *s: torch.randn(*s, dtype=torch.bfloat16) * 0.4)(B, S, Dm)),
            "w_gate": _w((lambda *s: torch.randn(*s, dtype=torch.bfloat16) * 1.6)(Dm, Df) * (Dm ** -0.5)),
            "w_up": _w((lambda *s: torch.randn(*s, dtype=torch.bfloat16) * 1.6)(Dm, Df) * (Dm ** -0.5)),
            "w_down": _w((lambda *s: torch.randn(*s, dtype=torch.bfloat16) * 1.6)(Df, Dm) * (Df ** -0.5)),
        }
    _B_in = _B_setup()

    return {
        "A_x": _A_in["x"],
        "A_k_cache": _A_in["k_cache"],
        "A_v_cache": _A_in["v_cache"],
        "A_wq": _A_in["wq"],
        "A_wo": _A_in["wo"],
        "B_x": _B_in["x"],
        "B_w_gate": _B_in["w_gate"],
        "B_w_up": _B_in["w_up"],
        "B_w_down": _B_in["w_down"],
    }

def reference(A_x, A_k_cache, A_v_cache, A_wq, A_wo, B_x, B_w_gate, B_w_up, B_w_down):
    def _A_ref(x, k_cache, v_cache, wq, wo):
        B, Sq, D = x.shape
        Hq, Dh = 32, 128
        Hkv = k_cache.shape[1]
        rep = Hq // Hkv
        q = (lambda x, *d: x.permute(*d))((x @ wq).reshape(B, Sq, Hq, Dh), 0, 2, 1, 3)
        k = (lambda x, n, axis: torch.repeat_interleave(x, n, dim=axis))(k_cache, rep, axis=1)
        v = (lambda x, n, axis: torch.repeat_interleave(x, n, dim=axis))(v_cache, rep, axis=1)
        scores = torch.einsum("bhqd,bhkd->bhqk", q, k) * (Dh ** -0.5)
        p = _softmax(scores, axis=-1)
        o = torch.einsum("bhqk,bhkd->bhqd", p, v)
        return (lambda x, *d: x.permute(*d))(o, 0, 2, 1, 3).reshape(B, Sq, Hq * Dh) @ wo

    def _B_ref(x, w_gate, w_up, w_down):
        g = torch.einsum("bsd,df->bsf", x, w_gate)
        u = torch.einsum("bsd,df->bsf", x, w_up)
        h = _gelu(g) * u
        return torch.einsum("bsf,fd->bsd", h, w_down)

    x = A_x
    xn = _layernorm(x, axis=-1)
    s = _A_ref(xn, A_k_cache, A_v_cache, A_wq, A_wo)
    g = _silu(_B_ref(xn, B_w_gate, B_w_up, B_w_down))
    return x + s * g
```

```asm
; @launch grid=(256,1,1) block=(512,1,1) lds=102400
.amdgcn_target "amdgcn-amd-amdhsa--gfx950"
.text
.globl recurrent_scan__gqa_block_cached__glu_gated_geglu__decode_kernel
.p2align 8
.type recurrent_scan__gqa_block_cached__glu_gated_geglu__decode_kernel,@function
recurrent_scan__gqa_block_cached__glu_gated_geglu__decode_kernel:
    s_cmp_ge_u32 s2, 256
    s_cbranch_scc1 L_end
    s_load_dwordx16 s[4:19], s[0:1], 0
    s_load_dwordx8 s[20:27], s[0:1], 64
    v_and_b32 v1, 63, v0
    v_lshrrev_b32 v2, 4, v1
    v_and_b32 v3, 15, v1
    v_lshrrev_b32 v4, 6, v0
    s_mov_b32 s30, 0x05040100
    v_readfirstlane_b32 s28, v4
    s_mov_b32 s31, 0x07060302
    s_waitcnt lgkmcnt(0)
    s_cmp_lg_u32 s28, 7
    s_cbranch_scc1 L_nopref
    s_cmp_ge_u32 s2, 16
    s_cbranch_scc1 L_nopref
    s_getpc_b64 s[44:45]
    v_lshlrev_b32 v4, 4, v1
    global_load_dwordx4 v[180:183], v4, s[44:45]
    v_add_u32 v4, 1024, v4
    global_load_dwordx4 v[180:183], v4, s[44:45]
    v_add_u32 v4, 1024, v4
    global_load_dwordx4 v[180:183], v4, s[44:45]
    v_add_u32 v4, 1024, v4
    global_load_dwordx4 v[180:183], v4, s[44:45]
    v_add_u32 v4, 1024, v4
    global_load_dwordx4 v[180:183], v4, s[44:45]
    v_add_u32 v4, 1024, v4
    global_load_dwordx4 v[180:183], v4, s[44:45]
    v_add_u32 v4, 1024, v4
    global_load_dwordx4 v[180:183], v4, s[44:45]
    v_add_u32 v4, 1024, v4
    global_load_dwordx4 v[180:183], v4, s[44:45]
    v_add_u32 v4, 1024, v4
    global_load_dwordx4 v[180:183], v4, s[44:45]
    v_add_u32 v4, 1024, v4
    global_load_dwordx4 v[180:183], v4, s[44:45]
    v_add_u32 v4, 1024, v4
    global_load_dwordx4 v[180:183], v4, s[44:45]
    v_add_u32 v4, 1024, v4
    global_load_dwordx4 v[180:183], v4, s[44:45]
    v_add_u32 v4, 1024, v4
    global_load_dwordx4 v[180:183], v4, s[44:45]
    v_add_u32 v4, 1024, v4
    global_load_dwordx4 v[180:183], v4, s[44:45]
    v_add_u32 v4, 1024, v4
L_nopref:
    s_or_b32 s44, s2, s28
    s_cmp_lg_u32 s44, 0
    s_cbranch_scc1 L_nononce
    s_memrealtime s[44:45]
    s_waitcnt lgkmcnt(0)
    s_or_b32 s44, s44, 1
    v_mov_b32 v4, s44
    v_mov_b32 v5, 0
    s_mov_b64 exec, 1
    global_store_dword v5, v4, s[24:25] sc1
    s_mov_b64 exec, -1
L_nononce:
    s_sub_u32 s58, s28, 1
    s_cmp_ge_u32 s58, 4
    s_cbranch_scc1 L_nox
    s_lshl_b32 s44, s58, 11
    v_lshlrev_b32 v4, 4, v1
    v_add_u32 v4, s44, v4
    global_load_dwordx4 v[152:155], v4, s[4:5]
    global_load_dwordx4 v[156:159], v4, s[4:5] offset:1024
L_nox:
    s_lshr_b32 s44, s2, 5
    s_lshl_b32 s44, s44, 7
    s_and_b32 s45, s28, 3
    s_lshl_b32 s45, s45, 5
    s_add_u32 s47, s44, s45
    s_lshl_b32 s46, s47, 13
    s_and_b32 s45, s2, 31
    s_lshl_b32 s45, s45, 8
    s_add_u32 s46, s46, s45
    s_add_u32 s32, s10, s46
    s_addc_u32 s33, s11, 0
    s_lshr_b32 s44, s2, 1
    s_lshl_b32 s44, s44, 16
    s_and_b32 s45, s2, 1
    s_lshl_b32 s45, s45, 10
    s_add_u32 s44, s44, s45
    s_and_b32 s45, s28, 3
    s_lshl_b32 s45, s45, 8
    s_add_u32 s44, s44, s45
    s_add_u32 s42, s12, s44
    s_addc_u32 s43, s13, 0
    s_cmp_ge_u32 s2, 112
    s_cselect_b32 s48, 1, 0
    s_mul_i32 s44, s48, 112
    s_sub_u32 s44, s2, s44
    s_mul_i32 s45, s44, 2341
    s_lshr_b32 s49, s45, 16
    s_mul_i32 s45, s49, 28
    s_sub_u32 s50, s44, s45
    s_lshl_b32 s44, s49, 8
    s_lshl_b32 s45, s28, 5
    s_add_u32 s51, s44, s45
    s_mul_i32 s44, s51, 7168
    s_lshl_b32 s45, s50, 8
    s_add_u32 s44, s44, s45
    s_cmp_eq_u32 s48, 0
    s_cselect_b32 s52, s16, s18
    s_cselect_b32 s53, s17, s19
    s_add_u32 s34, s52, s44
    s_addc_u32 s35, s53, 0
    s_lshl_b32 s44, s2, 17
    s_lshl_b32 s45, s28, 14
    s_add_u32 s44, s44, s45
    s_add_u32 s36, s6, s44
    s_addc_u32 s37, s7, 0
    s_add_u32 s38, s8, s44
    s_addc_u32 s39, s9, 0
    s_lshr_b32 s44, s2, 2
    s_lshl_b32 s44, s44, 6
    s_lshr_b32 s45, s28, 1
    s_and_b32 s45, s45, 1
    s_lshl_b32 s45, s45, 5
    s_add_u32 s44, s44, s45
    s_lshl_b32 s44, s44, 11
    s_and_b32 s45, s2, 3
    s_lshl_b32 s45, s45, 9
    s_add_u32 s44, s44, s45
    s_and_b32 s45, s28, 1
    s_lshl_b32 s45, s45, 8
    s_add_u32 s44, s44, s45
    s_add_u32 s40, s20, s44
    s_addc_u32 s41, s21, 0
    s_cmp_ge_u32 s58, 4
    s_cbranch_scc1 L_noln
    s_waitcnt vmcnt(0)
    v_lshlrev_b32 v160, 16, v152
    v_and_b32 v161, 0xffff0000, v152
    v_lshlrev_b32 v162, 16, v153
    v_and_b32 v163, 0xffff0000, v153
    v_lshlrev_b32 v164, 16, v154
    v_and_b32 v165, 0xffff0000, v154
    v_lshlrev_b32 v166, 16, v155
    v_and_b32 v167, 0xffff0000, v155
    v_lshlrev_b32 v168, 16, v156
    v_and_b32 v169, 0xffff0000, v156
    v_lshlrev_b32 v170, 16, v157
    v_and_b32 v171, 0xffff0000, v157
    v_lshlrev_b32 v172, 16, v158
    v_and_b32 v173, 0xffff0000, v158
    v_lshlrev_b32 v174, 16, v159
    v_and_b32 v175, 0xffff0000, v159
    v_add_f32 v4, v160, v161
    v_add_f32 v4, v4, v162
    v_add_f32 v4, v4, v163
    v_add_f32 v4, v4, v164
    v_add_f32 v4, v4, v165
    v_add_f32 v4, v4, v166
    v_add_f32 v4, v4, v167
    v_add_f32 v4, v4, v168
    v_add_f32 v4, v4, v169
    v_add_f32 v4, v4, v170
    v_add_f32 v4, v4, v171
    v_add_f32 v4, v4, v172
    v_add_f32 v4, v4, v173
    v_add_f32 v4, v4, v174
    v_add_f32 v4, v4, v175
    s_nop 1
    v_add_f32_dpp v4, v4, v4 row_ror:8 row_mask:0xf bank_mask:0xf
    s_nop 1
    v_add_f32_dpp v4, v4, v4 row_ror:4 row_mask:0xf bank_mask:0xf
    s_nop 1
    v_add_f32_dpp v4, v4, v4 row_ror:2 row_mask:0xf bank_mask:0xf
    s_nop 1
    v_add_f32_dpp v4, v4, v4 row_ror:1 row_mask:0xf bank_mask:0xf
    v_mov_b32 v5, v4
    s_nop 1
    v_permlane16_swap_b32 v4, v5
    s_nop 1
    v_add_f32 v4, v4, v5
    v_mov_b32 v5, v4
    s_nop 1
    v_permlane32_swap_b32 v4, v5
    s_nop 1
    v_add_f32 v4, v4, v5
    v_mul_f32 v4, 0x3a800000, v4
    v_sub_f32 v5, v160, v4
    v_mul_f32 v6, v5, v5
    v_sub_f32 v5, v161, v4
    v_fmac_f32 v6, v5, v5
    v_sub_f32 v5, v162, v4
    v_fmac_f32 v6, v5, v5
    v_sub_f32 v5, v163, v4
    v_fmac_f32 v6, v5, v5
    v_sub_f32 v5, v164, v4
    v_fmac_f32 v6, v5, v5
    v_sub_f32 v5, v165, v4
    v_fmac_f32 v6, v5, v5
    v_sub_f32 v5, v166, v4
    v_fmac_f32 v6, v5, v5
    v_sub_f32 v5, v167, v4
    v_fmac_f32 v6, v5, v5
    v_sub_f32 v5, v168, v4
    v_fmac_f32 v6, v5, v5
    v_sub_f32 v5, v169, v4
    v_fmac_f32 v6, v5, v5
    v_sub_f32 v5, v170, v4
    v_fmac_f32 v6, v5, v5
    v_sub_f32 v5, v171, v4
    v_fmac_f32 v6, v5, v5
    v_sub_f32 v5, v172, v4
    v_fmac_f32 v6, v5, v5
    v_sub_f32 v5, v173, v4
    v_fmac_f32 v6, v5, v5
    v_sub_f32 v5, v174, v4
    v_fmac_f32 v6, v5, v5
    v_sub_f32 v5, v175, v4
    v_fmac_f32 v6, v5, v5
    s_nop 1
    v_add_f32_dpp v6, v6, v6 row_ror:8 row_mask:0xf bank_mask:0xf
    s_nop 1
    v_add_f32_dpp v6, v6, v6 row_ror:4 row_mask:0xf bank_mask:0xf
    s_nop 1
    v_add_f32_dpp v6, v6, v6 row_ror:2 row_mask:0xf bank_mask:0xf
    s_nop 1
    v_add_f32_dpp v6, v6, v6 row_ror:1 row_mask:0xf bank_mask:0xf
    v_mov_b32 v5, v6
    s_nop 1
    v_permlane16_swap_b32 v6, v5
    s_nop 1
    v_add_f32 v6, v6, v5
    v_mov_b32 v5, v6
    s_nop 1
    v_permlane32_swap_b32 v6, v5
    s_nop 1
    v_add_f32 v6, v6, v5
    v_mul_f32 v6, 0x3a800000, v6
    v_cvt_pk_bf16_f32 v4, v4, v4
    v_and_b32 v4, 0xffff0000, v4
    v_cvt_pk_bf16_f32 v6, v6, v6
    v_and_b32 v6, 0xffff0000, v6
    v_add_f32 v6, 0x3727c5ac, v6
    v_cvt_pk_bf16_f32 v6, v6, v6
    v_and_b32 v6, 0xffff0000, v6
    v_sqrt_f32 v6, v6
    s_nop 0
    v_cvt_pk_bf16_f32 v6, v6, v6
    v_and_b32 v6, 0xffff0000, v6
    v_rcp_f32 v7, v6
    s_nop 0
    v_sub_f32 v5, v160, v4
    v_cvt_pk_bf16_f32 v5, v5, v5
    v_and_b32 v5, 0xffff0000, v5
    v_mul_f32 v8, v5, v7
    v_fma_f32 v9, -v8, v6, v5
    v_fma_f32 v160, v9, v7, v8
    v_sub_f32 v5, v161, v4
    v_cvt_pk_bf16_f32 v5, v5, v5
    v_and_b32 v5, 0xffff0000, v5
    v_mul_f32 v8, v5, v7
    v_fma_f32 v9, -v8, v6, v5
    v_fma_f32 v161, v9, v7, v8
    v_sub_f32 v5, v162, v4
    v_cvt_pk_bf16_f32 v5, v5, v5
    v_and_b32 v5, 0xffff0000, v5
    v_mul_f32 v8, v5, v7
    v_fma_f32 v9, -v8, v6, v5
    v_fma_f32 v162, v9, v7, v8
    v_sub_f32 v5, v163, v4
    v_cvt_pk_bf16_f32 v5, v5, v5
    v_and_b32 v5, 0xffff0000, v5
    v_mul_f32 v8, v5, v7
    v_fma_f32 v9, -v8, v6, v5
    v_fma_f32 v163, v9, v7, v8
    v_sub_f32 v5, v164, v4
    v_cvt_pk_bf16_f32 v5, v5, v5
    v_and_b32 v5, 0xffff0000, v5
    v_mul_f32 v8, v5, v7
    v_fma_f32 v9, -v8, v6, v5
    v_fma_f32 v164, v9, v7, v8
    v_sub_f32 v5, v165, v4
    v_cvt_pk_bf16_f32 v5, v5, v5
    v_and_b32 v5, 0xffff0000, v5
    v_mul_f32 v8, v5, v7
    v_fma_f32 v9, -v8, v6, v5
    v_fma_f32 v165, v9, v7, v8
    v_sub_f32 v5, v166, v4
    v_cvt_pk_bf16_f32 v5, v5, v5
    v_and_b32 v5, 0xffff0000, v5
    v_mul_f32 v8, v5, v7
    v_fma_f32 v9, -v8, v6, v5
    v_fma_f32 v166, v9, v7, v8
    v_sub_f32 v5, v167, v4
    v_cvt_pk_bf16_f32 v5, v5, v5
    v_and_b32 v5, 0xffff0000, v5
    v_mul_f32 v8, v5, v7
    v_fma_f32 v9, -v8, v6, v5
    v_fma_f32 v167, v9, v7, v8
    v_sub_f32 v5, v168, v4
    v_cvt_pk_bf16_f32 v5, v5, v5
    v_and_b32 v5, 0xffff0000, v5
    v_mul_f32 v8, v5, v7
    v_fma_f32 v9, -v8, v6, v5
    v_fma_f32 v168, v9, v7, v8
    v_sub_f32 v5, v169, v4
    v_cvt_pk_bf16_f32 v5, v5, v5
    v_and_b32 v5, 0xffff0000, v5
    v_mul_f32 v8, v5, v7
    v_fma_f32 v9, -v8, v6, v5
    v_fma_f32 v169, v9, v7, v8
    v_sub_f32 v5, v170, v4
    v_cvt_pk_bf16_f32 v5, v5, v5
    v_and_b32 v5, 0xffff0000, v5
    v_mul_f32 v8, v5, v7
    v_fma_f32 v9, -v8, v6, v5
    v_fma_f32 v170, v9, v7, v8
    v_sub_f32 v5, v171, v4
    v_cvt_pk_bf16_f32 v5, v5, v5
    v_and_b32 v5, 0xffff0000, v5
    v_mul_f32 v8, v5, v7
    v_fma_f32 v9, -v8, v6, v5
    v_fma_f32 v171, v9, v7, v8
    v_sub_f32 v5, v172, v4
    v_cvt_pk_bf16_f32 v5, v5, v5
    v_and_b32 v5, 0xffff0000, v5
    v_mul_f32 v8, v5, v7
    v_fma_f32 v9, -v8, v6, v5
    v_fma_f32 v172, v9, v7, v8
    v_sub_f32 v5, v173, v4
    v_cvt_pk_bf16_f32 v5, v5, v5
    v_and_b32 v5, 0xffff0000, v5
    v_mul_f32 v8, v5, v7
    v_fma_f32 v9, -v8, v6, v5
    v_fma_f32 v173, v9, v7, v8
    v_sub_f32 v5, v174, v4
    v_cvt_pk_bf16_f32 v5, v5, v5
    v_and_b32 v5, 0xffff0000, v5
    v_mul_f32 v8, v5, v7
    v_fma_f32 v9, -v8, v6, v5
    v_fma_f32 v174, v9, v7, v8
    v_sub_f32 v5, v175, v4
    v_cvt_pk_bf16_f32 v5, v5, v5
    v_and_b32 v5, 0xffff0000, v5
    v_mul_f32 v8, v5, v7
    v_fma_f32 v9, -v8, v6, v5
    v_fma_f32 v175, v9, v7, v8
    v_cvt_pk_bf16_f32 v152, v160, v161
    v_cvt_pk_bf16_f32 v153, v162, v163
    v_cvt_pk_bf16_f32 v154, v164, v165
    v_cvt_pk_bf16_f32 v155, v166, v167
    v_cvt_pk_bf16_f32 v156, v168, v169
    v_cvt_pk_bf16_f32 v157, v170, v171
    v_cvt_pk_bf16_f32 v158, v172, v173
    v_cvt_pk_bf16_f32 v159, v174, v175
    s_lshl_b32 s44, s58, 11
    v_lshlrev_b32 v4, 4, v1
    v_add_u32 v4, s44, v4
    ds_write_b128 v4, v[152:155] offset:0
    ds_write_b128 v4, v[156:159] offset:1024
L_noln:
    s_cmp_lt_u32 s28, 4
    s_cselect_b64 exec, -1, 0
    v_mul_u32_u24 v4, 65536, v2
    v_lshl_add_u32 v4, v3, 4, v4
    global_load_dwordx4 v[24:27], v4, s[32:33] nt
    v_add_u32 v4, 8192, v4
    global_load_dwordx4 v[28:31], v4, s[32:33] nt
    v_add_u32 v4, 8192, v4
    global_load_dwordx4 v[32:35], v4, s[32:33] nt
    v_add_u32 v4, 8192, v4
    global_load_dwordx4 v[36:39], v4, s[32:33] nt
    v_add_u32 v4, 8192, v4
    global_load_dwordx4 v[40:43], v4, s[32:33] nt
    v_add_u32 v4, 8192, v4
    global_load_dwordx4 v[44:47], v4, s[32:33] nt
    v_add_u32 v4, 8192, v4
    global_load_dwordx4 v[48:51], v4, s[32:33] nt
    v_add_u32 v4, 8192, v4
    global_load_dwordx4 v[52:55], v4, s[32:33] nt
    s_cmp_lt_u32 s2, 224
    s_cselect_b64 exec, -1, 0
    v_mul_u32_u24 v5, 57344, v2
    v_lshl_add_u32 v5, v3, 4, v5
    global_load_dwordx4 v[56:59], v5, s[34:35] nt
    v_add_u32 v5, 7168, v5
    global_load_dwordx4 v[60:63], v5, s[34:35] nt
    v_add_u32 v5, 7168, v5
    global_load_dwordx4 v[64:67], v5, s[34:35] nt
    v_add_u32 v5, 7168, v5
    global_load_dwordx4 v[68:71], v5, s[34:35] nt
    v_add_u32 v5, 7168, v5
    global_load_dwordx4 v[72:75], v5, s[34:35] nt
    v_add_u32 v5, 7168, v5
    global_load_dwordx4 v[76:79], v5, s[34:35] nt
    v_add_u32 v5, 7168, v5
    global_load_dwordx4 v[80:83], v5, s[34:35] nt
    v_add_u32 v5, 7168, v5
    global_load_dwordx4 v[84:87], v5, s[34:35] nt
    s_cmp_ge_u32 s28, 3
    s_cselect_b64 exec, -1, 0
    v_lshlrev_b32 v6, 8, v3
    v_lshl_add_u32 v6, v2, 4, v6
    global_load_dwordx4 a[0:3], v6, s[36:37] offset:0 nt
    global_load_dwordx4 a[4:7], v6, s[36:37] offset:64 nt
    global_load_dwordx4 a[8:11], v6, s[36:37] offset:128 nt
    global_load_dwordx4 a[12:15], v6, s[36:37] offset:192 nt
    s_mov_b64 exec, -1
    s_cmp_lg_u32 s28, 0
    s_cbranch_scc1 L_noclr
    v_mov_b32 v4, 8192
    v_mov_b32 v6, 0
    v_mov_b32 v7, 0
    ds_write_b64 v4, v[6:7] offset:8
    ds_write_b64 v4, v[6:7] offset:16
    ds_write_b64 v4, v[6:7] offset:24
L_noclr:
    s_waitcnt lgkmcnt(0)
    s_barrier
    v_and_b32 v4, 3, v3
    v_lshlrev_b32 v4, 11, v4
    v_lshl_add_u32 v4, v2, 4, v4
    s_lshl_b32 s44, s28, 11
    v_lshlrev_b32 v6, 5, v3
    v_add_u32 v6, s44, v6
    s_cmp_ge_u32 s28, 4
    s_cbranch_scc1 L_noq
    s_lshl_b32 s44, s47, 1
    v_add_u32 v5, s44, v4
    ds_read_b128 v[20:23], v5 offset:0
    s_waitcnt vmcnt(12) lgkmcnt(0)
    v_perm_b32 v152, v28, v24, s30
    v_perm_b32 v153, v36, v32, s30
    v_perm_b32 v154, v44, v40, s30
    v_perm_b32 v155, v52, v48, s30
    v_perm_b32 v156, v28, v24, s31
    v_perm_b32 v157, v36, v32, s31
    v_perm_b32 v158, v44, v40, s31
    v_perm_b32 v159, v52, v48, s31
    v_perm_b32 v160, v29, v25, s30
    v_perm_b32 v161, v37, v33, s30
    v_perm_b32 v162, v45, v41, s30
    v_perm_b32 v163, v53, v49, s30
    v_perm_b32 v164, v29, v25, s31
    v_perm_b32 v165, v37, v33, s31
    v_perm_b32 v166, v45, v41, s31
    v_perm_b32 v167, v53, v49, s31
    v_perm_b32 v168, v30, v26, s30
    v_perm_b32 v169, v38, v34, s30
    v_perm_b32 v170, v46, v42, s30
    v_perm_b32 v171, v54, v50, s30
    v_perm_b32 v172, v30, v26, s31
    v_perm_b32 v173, v38, v34, s31
    v_perm_b32 v174, v46, v42, s31
    v_perm_b32 v175, v54, v50, s31
    v_perm_b32 v176, v31, v27, s30
    v_perm_b32 v177, v39, v35, s30
    v_perm_b32 v178, v47, v43, s30
    v_perm_b32 v179, v55, v51, s30
    v_perm_b32 v180, v31, v27, s31
    v_perm_b32 v181, v39, v35, s31
    v_perm_b32 v182, v47, v43, s31
    v_perm_b32 v183, v55, v51, s31
    s_nop 1
    v_mfma_f32_16x16x32_bf16 v[88:91], v[20:23], v[152:155], 0
    v_mfma_f32_16x16x32_bf16 v[92:95], v[20:23], v[156:159], 0
    v_mfma_f32_16x16x32_bf16 v[96:99], v[20:23], v[160:163], 0
    v_mfma_f32_16x16x32_bf16 v[100:103], v[20:23], v[164:167], 0
    v_mfma_f32_16x16x32_bf16 v[104:107], v[20:23], v[168:171], 0
    v_mfma_f32_16x16x32_bf16 v[108:111], v[20:23], v[172:175], 0
    v_mfma_f32_16x16x32_bf16 v[112:115], v[20:23], v[176:179], 0
    v_mfma_f32_16x16x32_bf16 v[116:119], v[20:23], v[180:183], 0
    v_add_u32 v7, 12288, v6
    s_nop 7
    v_mov_b32 v152, v88
    v_mov_b32 v153, v92
    v_mov_b32 v154, v96
    v_mov_b32 v155, v100
    v_mov_b32 v156, v104
    v_mov_b32 v157, v108
    v_mov_b32 v158, v112
    v_mov_b32 v159, v116
    v_mov_b32 v160, v89
    v_mov_b32 v161, v93
    v_mov_b32 v162, v97
    v_mov_b32 v163, v101
    v_mov_b32 v164, v105
    v_mov_b32 v165, v109
    v_mov_b32 v166, v113
    v_mov_b32 v167, v117
    v_mov_b32 v168, v90
    v_mov_b32 v169, v94
    v_mov_b32 v170, v98
    v_mov_b32 v171, v102
    v_mov_b32 v172, v106
    v_mov_b32 v173, v110
    v_mov_b32 v174, v114
    v_mov_b32 v175, v118
    v_mov_b32 v176, v91
    v_mov_b32 v177, v95
    v_mov_b32 v178, v99
    v_mov_b32 v179, v103
    v_mov_b32 v180, v107
    v_mov_b32 v181, v111
    v_mov_b32 v182, v115
    v_mov_b32 v183, v119
    s_mov_b32 exec_lo, 0xffff
    s_mov_b32 exec_hi, 0
    ds_write_b128 v7, v[152:155] offset:0
    ds_write_b128 v7, v[156:159] offset:16
    ds_write_b128 v7, v[160:163] offset:512
    ds_write_b128 v7, v[164:167] offset:528
    ds_write_b128 v7, v[168:171] offset:1024
    ds_write_b128 v7, v[172:175] offset:1040
    ds_write_b128 v7, v[176:179] offset:1536
    ds_write_b128 v7, v[180:183] offset:1552
    s_mov_b64 exec, -1
L_noq:
    s_cmp_ge_u32 s2, 224
    s_cbranch_scc1 L_nogu
    s_lshl_b32 s44, s51, 1
    v_add_u32 v5, s44, v4
    ds_read_b128 v[20:23], v5 offset:0
    s_waitcnt vmcnt(4) lgkmcnt(0)
    v_perm_b32 v152, v60, v56, s30
    v_perm_b32 v153, v68, v64, s30
    v_perm_b32 v154, v76, v72, s30
    v_perm_b32 v155, v84, v80, s30
    v_perm_b32 v156, v60, v56, s31
    v_perm_b32 v157, v68, v64, s31
    v_perm_b32 v158, v76, v72, s31
    v_perm_b32 v159, v84, v80, s31
    v_perm_b32 v160, v61, v57, s30
    v_perm_b32 v161, v69, v65, s30
    v_perm_b32 v162, v77, v73, s30
    v_perm_b32 v163, v85, v81, s30
    v_perm_b32 v164, v61, v57, s31
    v_perm_b32 v165, v69, v65, s31
    v_perm_b32 v166, v77, v73, s31
    v_perm_b32 v167, v85, v81, s31
    v_perm_b32 v168, v62, v58, s30
    v_perm_b32 v169, v70, v66, s30
    v_perm_b32 v170, v78, v74, s30
    v_perm_b32 v171, v86, v82, s30
    v_perm_b32 v172, v62, v58, s31
    v_perm_b32 v173, v70, v66, s31
    v_perm_b32 v174, v78, v74, s31
    v_perm_b32 v175, v86, v82, s31
    v_perm_b32 v176, v63, v59, s30
    v_perm_b32 v177, v71, v67, s30
    v_perm_b32 v178, v79, v75, s30
    v_perm_b32 v179, v87, v83, s30
    v_perm_b32 v180, v63, v59, s31
    v_perm_b32 v181, v71, v67, s31
    v_perm_b32 v182, v79, v75, s31
    v_perm_b32 v183, v87, v83, s31
    s_nop 1
    v_mfma_f32_16x16x32_bf16 v[120:123], v[20:23], v[152:155], 0
    v_mfma_f32_16x16x32_bf16 v[124:127], v[20:23], v[156:159], 0
    v_mfma_f32_16x16x32_bf16 v[128:131], v[20:23], v[160:163], 0
    v_mfma_f32_16x16x32_bf16 v[132:135], v[20:23], v[164:167], 0
    v_mfma_f32_16x16x32_bf16 v[136:139], v[20:23], v[168:171], 0
    v_mfma_f32_16x16x32_bf16 v[140:143], v[20:23], v[172:175], 0
    v_mfma_f32_16x16x32_bf16 v[144:147], v[20:23], v[176:179], 0
    v_mfma_f32_16x16x32_bf16 v[148:151], v[20:23], v[180:183], 0
    v_add_u32 v7, 28672, v6
    s_nop 7
    v_mov_b32 v152, v120
    v_mov_b32 v153, v124
    v_mov_b32 v154, v128
    v_mov_b32 v155, v132
    v_mov_b32 v156, v136
    v_mov_b32 v157, v140
    v_mov_b32 v158, v144
    v_mov_b32 v159, v148
    v_mov_b32 v160, v121
    v_mov_b32 v161, v125
    v_mov_b32 v162, v129
    v_mov_b32 v163, v133
    v_mov_b32 v164, v137
    v_mov_b32 v165, v141
    v_mov_b32 v166, v145
    v_mov_b32 v167, v149
    v_mov_b32 v168, v122
    v_mov_b32 v169, v126
    v_mov_b32 v170, v130
    v_mov_b32 v171, v134
    v_mov_b32 v172, v138
    v_mov_b32 v173, v142
    v_mov_b32 v174, v146
    v_mov_b32 v175, v150
    v_mov_b32 v176, v123
    v_mov_b32 v177, v127
    v_mov_b32 v178, v131
    v_mov_b32 v179, v135
    v_mov_b32 v180, v139
    v_mov_b32 v181, v143
    v_mov_b32 v182, v147
    v_mov_b32 v183, v151
    s_mov_b32 exec_lo, 0xffff
    s_mov_b32 exec_hi, 0
    ds_write_b128 v7, v[152:155] offset:0
    ds_write_b128 v7, v[156:159] offset:16
    ds_write_b128 v7, v[160:163] offset:512
    ds_write_b128 v7, v[164:167] offset:528
    ds_write_b128 v7, v[168:171] offset:1024
    ds_write_b128 v7, v[172:175] offset:1040
    ds_write_b128 v7, v[176:179] offset:1536
    ds_write_b128 v7, v[180:183] offset:1552
    s_mov_b64 exec, -1
L_nogu:
    s_cmp_lg_u32 s28, 0
    s_cbranch_scc1 L_nononce2
    s_mov_b32 s62, 0
    v_mov_b32 v5, 0
L_noncepoll:
    global_load_dword v4, v5, s[24:25] sc1
    s_waitcnt vmcnt(0)
    v_readfirstlane_b32 s44, v4
    s_cmp_lg_u32 s44, 0
    s_cbranch_scc1 L_noncegot
    s_add_u32 s62, s62, 1
    s_cmp_ge_u32 s62, 200000
    s_cbranch_scc1 L_noncegot
    s_sleep 1
    s_branch L_noncepoll
L_noncegot:
    v_mov_b32 v5, 8192
    ds_write_b32 v5, v4
L_nononce2:
    s_waitcnt lgkmcnt(0)
    s_barrier
    v_mov_b32 v5, 8192
    ds_read_b32 v4, v5
    v_mov_b32 v184, 0xff
    s_waitcnt lgkmcnt(0)
    v_readfirstlane_b32 s29, v4
    s_nop 3
    s_and_b32 s96, s29, 0xff
    s_bfe_u32 s97, s29, 0x80008
    s_bfe_u32 s98, s29, 0x80010
    s_lshr_b32 s99, s29, 24
    s_cmp_lt_u32 s28, 4
    s_cbranch_scc1 L_pubdone
    s_and_b32 s44, s28, 1
    s_lshl_b32 s44, s44, 1
    v_lshrrev_b32 v6, 5, v1
    v_add_u32 v6, s44, v6
    v_and_b32 v7, 31, v1
    v_lshlrev_b32 v7, 4, v7
    s_cmp_lt_u32 s28, 6
    s_cbranch_scc0 L_pubgu
    s_lshr_b32 s46, s2, 5
    s_lshl_b32 s46, s46, 16
    s_and_b32 s54, s2, 31
    s_lshl_b32 s54, s54, 9
    s_add_u32 s46, s46, s54
    s_add_u32 s46, s46, 0
    v_lshl_add_u32 v4, v6, 9, v7
    ds_read_b128 v[152:155], v4 offset:12288
    ds_read_b128 v[156:159], v4 offset:14336
    ds_read_b128 v[160:163], v4 offset:16384
    ds_read_b128 v[164:167], v4 offset:18432
    v_lshlrev_b32 v5, 14, v6
    v_add3_u32 v5, v5, v7, s46
    s_waitcnt lgkmcnt(0)
    v_add_f32 v8, v152, v156
    v_add_f32 v9, v153, v157
    v_add_f32 v10, v154, v158
    v_add_f32 v11, v155, v159
    v_add_f32 v8, v8, v160
    v_add_f32 v9, v9, v161
    v_add_f32 v10, v10, v162
    v_add_f32 v11, v11, v163
    v_add_f32 v8, v8, v164
    v_add_f32 v9, v9, v165
    v_add_f32 v10, v10, v166
    v_add_f32 v11, v11, v167
    s_branch L_pubgo
L_pubgu:
    s_cmp_ge_u32 s2, 224
    s_cbranch_scc1 L_pubdone
    s_lshl_b32 s46, s48, 2
    s_add_u32 s46, s46, s49
    s_mul_i32 s46, s46, 57344
    s_lshl_b32 s54, s50, 9
    s_add_u32 s46, s46, s54
    s_add_u32 s46, s46, 524288
    v_lshl_add_u32 v4, v6, 9, v7
    ds_read_b128 v[152:155], v4 offset:28672
    ds_read_b128 v[156:159], v4 offset:30720
    ds_read_b128 v[160:163], v4 offset:32768
    ds_read_b128 v[164:167], v4 offset:34816
    ds_read_b128 v[168:171], v4 offset:36864
    ds_read_b128 v[172:175], v4 offset:38912
    ds_read_b128 v[176:179], v4 offset:40960
    ds_read_b128 v[180:183], v4 offset:43008
    v_mul_u32_u24 v5, 14336, v6
    v_add3_u32 v5, v5, v7, s46
    s_waitcnt lgkmcnt(0)
    v_add_f32 v8, v152, v156
    v_add_f32 v9, v153, v157
    v_add_f32 v10, v154, v158
    v_add_f32 v11, v155, v159
    v_add_f32 v8, v8, v160
    v_add_f32 v9, v9, v161
    v_add_f32 v10, v10, v162
    v_add_f32 v11, v11, v163
    v_add_f32 v8, v8, v164
    v_add_f32 v9, v9, v165
    v_add_f32 v10, v10, v166
    v_add_f32 v11, v11, v167
    v_add_f32 v8, v8, v168
    v_add_f32 v9, v9, v169
    v_add_f32 v10, v10, v170
    v_add_f32 v11, v11, v171
    v_add_f32 v8, v8, v172
    v_add_f32 v9, v9, v173
    v_add_f32 v10, v10, v174
    v_add_f32 v11, v11, v175
    v_add_f32 v8, v8, v176
    v_add_f32 v9, v9, v177
    v_add_f32 v10, v10, v178
    v_add_f32 v11, v11, v179
    v_add_f32 v8, v8, v180
    v_add_f32 v9, v9, v181
    v_add_f32 v10, v10, v182
    v_add_f32 v11, v11, v183
L_pubgo:
    v_bfi_b32 v8, v184, s96, v8
    v_bfi_b32 v9, v184, s97, v9
    v_bfi_b32 v10, v184, s98, v10
    v_bfi_b32 v11, v184, s99, v11
    global_store_dwordx4 v5, v[8:11], s[26:27] sc1
L_pubdone:
    s_cmp_ge_u32 s28, 3
    s_cbranch_scc1 L_bulk
    v_lshlrev_b32 v6, 8, v3
    v_lshl_add_u32 v6, v2, 4, v6
    s_waitcnt vmcnt(7)
    global_load_dwordx4 a[0:3], v6, s[36:37] offset:0 nt
    s_waitcnt vmcnt(7)
    global_load_dwordx4 a[4:7], v6, s[36:37] offset:64 nt
    s_waitcnt vmcnt(7)
    global_load_dwordx4 a[8:11], v6, s[36:37] offset:128 nt
    s_waitcnt vmcnt(7)
    global_load_dwordx4 a[12:15], v6, s[36:37] offset:192 nt
    v_add_u32 v6, 4096, v6
    s_waitcnt vmcnt(7)
    global_load_dwordx4 a[16:19], v6, s[36:37] offset:0 nt
    s_waitcnt vmcnt(7)
    global_load_dwordx4 a[20:23], v6, s[36:37] offset:64 nt
    s_waitcnt vmcnt(7)
    global_load_dwordx4 a[24:27], v6, s[36:37] offset:128 nt
    s_waitcnt vmcnt(7)
    global_load_dwordx4 a[28:31], v6, s[36:37] offset:192 nt
    v_add_u32 v6, 4096, v6
    s_waitcnt vmcnt(7)
    global_load_dwordx4 a[32:35], v6, s[36:37] offset:0 nt
    s_waitcnt vmcnt(7)
    global_load_dwordx4 a[36:39], v6, s[36:37] offset:64 nt
    s_waitcnt vmcnt(7)
    global_load_dwordx4 a[40:43], v6, s[36:37] offset:128 nt
    s_waitcnt vmcnt(7)
    global_load_dwordx4 a[44:47], v6, s[36:37] offset:192 nt
    v_add_u32 v6, 4096, v6
    s_waitcnt vmcnt(7)
    global_load_dwordx4 a[48:51], v6, s[36:37] offset:0 nt
    s_waitcnt vmcnt(7)
    global_load_dwordx4 a[52:55], v6, s[36:37] offset:64 nt
    s_waitcnt vmcnt(7)
    global_load_dwordx4 a[56:59], v6, s[36:37] offset:128 nt
    s_waitcnt vmcnt(7)
    global_load_dwordx4 a[60:63], v6, s[36:37] offset:192 nt
    s_cmp_lg_u32 s28, 2
    s_cbranch_scc1 L_notl1
    s_lshl_b32 s44, s2, 8
    s_add_u32 s44, s44, 0
    v_lshlrev_b32 v4, 16, v2
    v_lshl_add_u32 v4, v3, 4, v4
    v_add_u32 v4, s44, v4
    v_add_u32 v5, 0x40000, v4
    s_mov_b32 s62, 0
L_spin_1:
    global_load_dwordx4 v[24:27], v4, s[26:27] sc1
    global_load_dwordx4 v[28:31], v5, s[26:27] sc1
    s_waitcnt vmcnt(0)
    v_xor_b32 v8, s96, v24
    v_xor_b32 v10, s97, v25
    v_or_b32 v8, v8, v10
    v_xor_b32 v10, s98, v26
    v_xor_b32 v11, s99, v27
    v_or3_b32 v8, v8, v10, v11
    v_xor_b32 v10, s96, v28
    v_xor_b32 v11, s97, v29
    v_or3_b32 v8, v8, v10, v11
    v_xor_b32 v10, s98, v30
    v_xor_b32 v11, s99, v31
    v_or3_b32 v8, v8, v10, v11
    v_and_b32 v8, 0xff, v8
    v_cmp_ne_u32 vcc, 0, v8
    s_nop 1
    s_cbranch_vccz L_spun_2
    s_add_u32 s62, s62, 1
    s_cmp_ge_u32 s62, 200000
    s_cbranch_scc1 L_spun_2
    s_sleep 4
    s_branch L_spin_1
L_spun_2:
    v_and_b32 v24, 0xffffff00, v24
    v_and_b32 v25, 0xffffff00, v25
    v_and_b32 v26, 0xffffff00, v26
    v_and_b32 v27, 0xffffff00, v27
    v_and_b32 v28, 0xffffff00, v28
    v_and_b32 v29, 0xffffff00, v29
    v_and_b32 v30, 0xffffff00, v30
    v_and_b32 v31, 0xffffff00, v31
    v_add_f32 v8, v24, v28
    v_add_f32 v9, v25, v29
    v_add_f32 v10, v26, v30
    v_add_f32 v11, v27, v31
    v_mov_b32 v152, v8
    v_mov_b32 v153, v9
    v_mov_b32 v154, v10
    v_mov_b32 v155, v11
    v_permlane16_swap_b32 v8, v152
    v_permlane16_swap_b32 v9, v153
    v_permlane16_swap_b32 v10, v154
    v_permlane16_swap_b32 v11, v155
    v_add_f32 v8, v8, v152
    v_add_f32 v9, v9, v153
    v_add_f32 v10, v10, v154
    v_add_f32 v11, v11, v155
    v_mov_b32 v152, v8
    v_mov_b32 v153, v9
    v_mov_b32 v154, v10
    v_mov_b32 v155, v11
    v_permlane32_swap_b32 v8, v152
    v_permlane32_swap_b32 v9, v153
    v_permlane32_swap_b32 v10, v154
    v_permlane32_swap_b32 v11, v155
    v_add_f32 v8, v8, v152
    v_add_f32 v9, v9, v153
    v_add_f32 v10, v10, v154
    v_add_f32 v11, v11, v155
    v_cvt_pk_bf16_f32 v8, v8, v8
    v_and_b32 v8, 0xffff0000, v8
    v_cvt_pk_bf16_f32 v9, v9, v9
    v_and_b32 v9, 0xffff0000, v9
    v_cvt_pk_bf16_f32 v10, v10, v10
    v_and_b32 v10, 0xffff0000, v10
    v_cvt_pk_bf16_f32 v11, v11, v11
    v_and_b32 v11, 0xffff0000, v11
    v_bfi_b32 v8, v184, s96, v8
    v_bfi_b32 v9, v184, s97, v9
    v_bfi_b32 v10, v184, s98, v10
    v_bfi_b32 v11, v184, s99, v11
    s_lshl_b32 s44, s2, 8
    s_add_u32 s44, s44, 1572864
    v_lshlrev_b32 v4, 4, v3
    v_add_u32 v4, s44, v4
    s_mov_b64 exec, 0xffff
    global_store_dwordx4 v4, v[8:11], s[26:27] sc1
    s_mov_b64 exec, -1
    s_branch L_vld
L_notl1:
    v_lshlrev_b32 v6, 10, v2
    v_lshl_add_u32 v6, v3, 4, v6
    v_add_u32 v6, 0x1000, v6
    s_waitcnt vmcnt(7)
    global_load_dwordx4 v[88:91], v6, s[38:39] offset:-4096 nt
    s_waitcnt vmcnt(7)
    global_load_dwordx4 v[92:95], v6, s[38:39] offset:-3840 nt
    s_waitcnt vmcnt(7)
    global_load_dwordx4 v[96:99], v6, s[38:39] offset:-3584 nt
    s_waitcnt vmcnt(7)
    global_load_dwordx4 v[100:103], v6, s[38:39] offset:-3328 nt
    s_waitcnt vmcnt(7)
    global_load_dwordx4 v[104:107], v6, s[38:39] offset:0 nt
    s_waitcnt vmcnt(7)
    global_load_dwordx4 v[108:111], v6, s[38:39] offset:256 nt
    s_waitcnt vmcnt(7)
    global_load_dwordx4 v[112:115], v6, s[38:39] offset:512 nt
    s_waitcnt vmcnt(7)
    global_load_dwordx4 v[116:119], v6, s[38:39] offset:768 nt
    v_add_u32 v6, 0x2000, v6
    s_waitcnt vmcnt(7)
    global_load_dwordx4 v[120:123], v6, s[38:39] offset:-4096 nt
    s_waitcnt vmcnt(7)
    global_load_dwordx4 v[124:127], v6, s[38:39] offset:-3840 nt
    s_waitcnt vmcnt(7)
    global_load_dwordx4 v[128:131], v6, s[38:39] offset:-3584 nt
    s_waitcnt vmcnt(7)
    global_load_dwordx4 v[132:135], v6, s[38:39] offset:-3328 nt
    s_waitcnt vmcnt(7)
    global_load_dwordx4 v[136:139], v6, s[38:39] offset:0 nt
    s_waitcnt vmcnt(7)
    global_load_dwordx4 v[140:143], v6, s[38:39] offset:256 nt
    s_waitcnt vmcnt(7)
    global_load_dwordx4 v[144:147], v6, s[38:39] offset:512 nt
    s_waitcnt vmcnt(7)
    global_load_dwordx4 v[148:151], v6, s[38:39] offset:768 nt
    v_mov_b32 v4, 8208
    v_mov_b32 v5, 1
    s_mov_b64 exec, 1
    ds_add_u32 v4, v5
    s_mov_b64 exec, -1
    s_cmp_eq_u32 s28, 1
    s_cbranch_scc1 L_hgather
    s_lshr_b32 s44, s2, 4
    s_lshl_b32 s44, s44, 12
    s_add_u32 s44, s44, 1572864
    v_lshlrev_b32 v4, 4, v1
    v_add_u32 v4, s44, v4
    s_mov_b32 s62, 0
L_spin_3:
    global_load_dwordx4 v[24:27], v4, s[26:27] offset:0 sc1
    global_load_dwordx4 v[28:31], v4, s[26:27] offset:1024 sc1
    global_load_dwordx4 v[32:35], v4, s[26:27] offset:2048 sc1
    global_load_dwordx4 v[36:39], v4, s[26:27] offset:3072 sc1
    s_waitcnt vmcnt(0)
    v_xor_b32 v8, s96, v24
    v_xor_b32 v10, s97, v25
    v_or_b32 v8, v8, v10
    v_xor_b32 v10, s98, v26
    v_xor_b32 v11, s99, v27
    v_or3_b32 v8, v8, v10, v11
    v_xor_b32 v10, s96, v28
    v_xor_b32 v11, s97, v29
    v_or3_b32 v8, v8, v10, v11
    v_xor_b32 v10, s98, v30
    v_xor_b32 v11, s99, v31
    v_or3_b32 v8, v8, v10, v11
    v_xor_b32 v10, s96, v32
    v_xor_b32 v11, s97, v33
    v_or3_b32 v8, v8, v10, v11
    v_xor_b32 v10, s98, v34
    v_xor_b32 v11, s99, v35
    v_or3_b32 v8, v8, v10, v11
    v_xor_b32 v10, s96, v36
    v_xor_b32 v11, s97, v37
    v_or3_b32 v8, v8, v10, v11
    v_xor_b32 v10, s98, v38
    v_xor_b32 v11, s99, v39
    v_or3_b32 v8, v8, v10, v11
    v_and_b32 v8, 0xff, v8
    v_cmp_ne_u32 vcc, 0, v8
    s_nop 1
    s_cbranch_vccz L_spun_4
    s_add_u32 s62, s62, 1
    s_cmp_ge_u32 s62, 200000
    s_cbranch_scc1 L_spun_4
    s_sleep 2
    s_branch L_spin_3
L_spun_4:
    v_lshrrev_b32 v5, 5, v1
    v_mul_u32_u24 v5, 272, v5
    v_and_b32 v6, 31, v1
    v_lshl_add_u32 v5, v6, 3, v5
    v_perm_b32 v6, v25, v24, s31
    v_perm_b32 v7, v27, v26, s31
    ds_write_b64 v5, v[6:7] offset:8448
    v_perm_b32 v6, v29, v28, s31
    v_perm_b32 v7, v31, v30, s31
    ds_write_b64 v5, v[6:7] offset:8992
    v_perm_b32 v6, v33, v32, s31
    v_perm_b32 v7, v35, v34, s31
    ds_write_b64 v5, v[6:7] offset:9536
    v_perm_b32 v6, v37, v36, s31
    v_perm_b32 v7, v39, v38, s31
    ds_write_b64 v5, v[6:7] offset:10080
    s_waitcnt lgkmcnt(0)
    v_mov_b32 v4, 8200
    v_mov_b32 v5, 1
    ds_write_b32 v4, v5
    s_branch L_late_ld
L_hgather:
    s_cmp_ge_u32 s2, 224
    s_cbranch_scc1 L_late_ld
    s_lshr_b32 s44, s2, 2
    s_lshl_b32 s44, s44, 8
    s_add_u32 s44, s44, 524288
    v_mul_u32_u24 v4, 14336, v2
    v_lshl_add_u32 v4, v3, 4, v4
    v_add_u32 v4, s44, v4
    s_mov_b32 s62, 0
L_spin_5:
    v_add_u32 v5, 0, v4
    global_load_dwordx4 v[24:27], v5, s[26:27] sc1
    v_add_u32 v5, 229376, v4
    global_load_dwordx4 v[28:31], v5, s[26:27] sc1
    v_add_u32 v5, 57344, v4
    global_load_dwordx4 v[32:35], v5, s[26:27] sc1
    v_add_u32 v5, 286720, v4
    global_load_dwordx4 v[36:39], v5, s[26:27] sc1
    v_add_u32 v5, 114688, v4
    global_load_dwordx4 v[40:43], v5, s[26:27] sc1
    v_add_u32 v5, 344064, v4
    global_load_dwordx4 v[44:47], v5, s[26:27] sc1
    v_add_u32 v5, 172032, v4
    global_load_dwordx4 v[48:51], v5, s[26:27] sc1
    v_add_u32 v5, 401408, v4
    global_load_dwordx4 v[52:55], v5, s[26:27] sc1
    s_waitcnt vmcnt(0)
    v_xor_b32 v8, s96, v24
    v_xor_b32 v10, s97, v25
    v_or_b32 v8, v8, v10
    v_xor_b32 v10, s98, v26
    v_xor_b32 v11, s99, v27
    v_or3_b32 v8, v8, v10, v11
    v_xor_b32 v10, s96, v28
    v_xor_b32 v11, s97, v29
    v_or3_b32 v8, v8, v10, v11
    v_xor_b32 v10, s98, v30
    v_xor_b32 v11, s99, v31
    v_or3_b32 v8, v8, v10, v11
    v_xor_b32 v10, s96, v32
    v_xor_b32 v11, s97, v33
    v_or3_b32 v8, v8, v10, v11
    v_xor_b32 v10, s98, v34
    v_xor_b32 v11, s99, v35
    v_or3_b32 v8, v8, v10, v11
    v_xor_b32 v10, s96, v36
    v_xor_b32 v11, s97, v37
    v_or3_b32 v8, v8, v10, v11
    v_xor_b32 v10, s98, v38
    v_xor_b32 v11, s99, v39
    v_or3_b32 v8, v8, v10, v11
    v_xor_b32 v10, s96, v40
    v_xor_b32 v11, s97, v41
    v_or3_b32 v8, v8, v10, v11
    v_xor_b32 v10, s98, v42
    v_xor_b32 v11, s99, v43
    v_or3_b32 v8, v8, v10, v11
    v_xor_b32 v10, s96, v44
    v_xor_b32 v11, s97, v45
    v_or3_b32 v8, v8, v10, v11
    v_xor_b32 v10, s98, v46
    v_xor_b32 v11, s99, v47
    v_or3_b32 v8, v8, v10, v11
    v_xor_b32 v10, s96, v48
    v_xor_b32 v11, s97, v49
    v_or3_b32 v8, v8, v10, v11
    v_xor_b32 v10, s98, v50
    v_xor_b32 v11, s99, v51
    v_or3_b32 v8, v8, v10, v11
    v_xor_b32 v10, s96, v52
    v_xor_b32 v11, s97, v53
    v_or3_b32 v8, v8, v10, v11
    v_xor_b32 v10, s98, v54
    v_xor_b32 v11, s99, v55
    v_or3_b32 v8, v8, v10, v11
    v_and_b32 v8, 0xff, v8
    v_cmp_ne_u32 vcc, 0, v8
    s_nop 1
    s_cbranch_vccz L_spun_6
    s_add_u32 s62, s62, 1
    s_cmp_ge_u32 s62, 200000
    s_cbranch_scc1 L_spun_6
    s_sleep 4
    s_branch L_spin_5
L_spun_6:
    v_and_b32 v24, 0xffffff00, v24
    v_and_b32 v25, 0xffffff00, v25
    v_and_b32 v26, 0xffffff00, v26
    v_and_b32 v27, 0xffffff00, v27
    v_and_b32 v28, 0xffffff00, v28
    v_and_b32 v29, 0xffffff00, v29
    v_and_b32 v30, 0xffffff00, v30
    v_and_b32 v31, 0xffffff00, v31
    v_and_b32 v32, 0xffffff00, v32
    v_and_b32 v33, 0xffffff00, v33
    v_and_b32 v34, 0xffffff00, v34
    v_and_b32 v35, 0xffffff00, v35
    v_and_b32 v36, 0xffffff00, v36
    v_and_b32 v37, 0xffffff00, v37
    v_and_b32 v38, 0xffffff00, v38
    v_and_b32 v39, 0xffffff00, v39
    v_and_b32 v40, 0xffffff00, v40
    v_and_b32 v41, 0xffffff00, v41
    v_and_b32 v42, 0xffffff00, v42
    v_and_b32 v43, 0xffffff00, v43
    v_and_b32 v44, 0xffffff00, v44
    v_and_b32 v45, 0xffffff00, v45
    v_and_b32 v46, 0xffffff00, v46
    v_and_b32 v47, 0xffffff00, v47
    v_and_b32 v48, 0xffffff00, v48
    v_and_b32 v49, 0xffffff00, v49
    v_and_b32 v50, 0xffffff00, v50
    v_and_b32 v51, 0xffffff00, v51
    v_and_b32 v52, 0xffffff00, v52
    v_and_b32 v53, 0xffffff00, v53
    v_and_b32 v54, 0xffffff00, v54
    v_and_b32 v55, 0xffffff00, v55
    v_add_f32 v152, v24, v32
    v_add_f32 v152, v152, v40
    v_add_f32 v152, v152, v48
    v_cvt_pk_bf16_f32 v152, v152, v152
    v_and_b32 v152, 0xffff0000, v152
    v_add_f32 v153, v25, v33
    v_add_f32 v153, v153, v41
    v_add_f32 v153, v153, v49
    v_cvt_pk_bf16_f32 v153, v153, v153
    v_and_b32 v153, 0xffff0000, v153
    v_add_f32 v154, v26, v34
    v_add_f32 v154, v154, v42
    v_add_f32 v154, v154, v50
    v_cvt_pk_bf16_f32 v154, v154, v154
    v_and_b32 v154, 0xffff0000, v154
    v_add_f32 v155, v27, v35
    v_add_f32 v155, v155, v43
    v_add_f32 v155, v155, v51
    v_cvt_pk_bf16_f32 v155, v155, v155
    v_and_b32 v155, 0xffff0000, v155
    v_add_f32 v156, v28, v36
    v_add_f32 v156, v156, v44
    v_add_f32 v156, v156, v52
    v_cvt_pk_bf16_f32 v156, v156, v156
    v_and_b32 v156, 0xffff0000, v156
    v_add_f32 v157, v29, v37
    v_add_f32 v157, v157, v45
    v_add_f32 v157, v157, v53
    v_cvt_pk_bf16_f32 v157, v157, v157
    v_and_b32 v157, 0xffff0000, v157
    v_add_f32 v158, v30, v38
    v_add_f32 v158, v158, v46
    v_add_f32 v158, v158, v54
    v_cvt_pk_bf16_f32 v158, v158, v158
    v_and_b32 v158, 0xffff0000, v158
    v_add_f32 v159, v31, v39
    v_add_f32 v159, v159, v47
    v_add_f32 v159, v159, v55
    v_cvt_pk_bf16_f32 v159, v159, v159
    v_and_b32 v159, 0xffff0000, v159
    v_mul_f32 v4, v152, v152
    v_mul_f32 v4, v4, v152
    v_mov_b32 v5, 0x3d372713
    v_fma_f32 v4, v4, v5, v152
    v_mul_f32 v4, 0xc0135761, v4
    v_exp_f32 v5, v4
    s_nop 0
    v_add_f32 v5, 1.0, v5
    v_rcp_f32 v5, v5
    s_nop 0
    v_mul_f32 v6, v152, v5
    v_cvt_pk_bf16_f32 v6, v6, v6
    v_and_b32 v6, 0xffff0000, v6
    v_mul_f32 v152, v6, v156
    v_mul_f32 v4, v153, v153
    v_mul_f32 v4, v4, v153
    v_mov_b32 v5, 0x3d372713
    v_fma_f32 v4, v4, v5, v153
    v_mul_f32 v4, 0xc0135761, v4
    v_exp_f32 v5, v4
    s_nop 0
    v_add_f32 v5, 1.0, v5
    v_rcp_f32 v5, v5
    s_nop 0
    v_mul_f32 v6, v153, v5
    v_cvt_pk_bf16_f32 v6, v6, v6
    v_and_b32 v6, 0xffff0000, v6
    v_mul_f32 v153, v6, v157
    v_mul_f32 v4, v154, v154
    v_mul_f32 v4, v4, v154
    v_mov_b32 v5, 0x3d372713
    v_fma_f32 v4, v4, v5, v154
    v_mul_f32 v4, 0xc0135761, v4
    v_exp_f32 v5, v4
    s_nop 0
    v_add_f32 v5, 1.0, v5
    v_rcp_f32 v5, v5
    s_nop 0
    v_mul_f32 v6, v154, v5
    v_cvt_pk_bf16_f32 v6, v6, v6
    v_and_b32 v6, 0xffff0000, v6
    v_mul_f32 v154, v6, v158
    v_mul_f32 v4, v155, v155
    v_mul_f32 v4, v4, v155
    v_mov_b32 v5, 0x3d372713
    v_fma_f32 v4, v4, v5, v155
    v_mul_f32 v4, 0xc0135761, v4
    v_exp_f32 v5, v4
    s_nop 0
    v_add_f32 v5, 1.0, v5
    v_rcp_f32 v5, v5
    s_nop 0
    v_mul_f32 v6, v155, v5
    v_cvt_pk_bf16_f32 v6, v6, v6
    v_and_b32 v6, 0xffff0000, v6
    v_mul_f32 v155, v6, v159
    v_lshlrev_b32 v5, 3, v1
    v_cvt_pk_bf16_f32 v6, v152, v153
    v_cvt_pk_bf16_f32 v7, v154, v155
    ds_write_b64 v5, v[6:7] offset:10752
    s_waitcnt lgkmcnt(0)
    v_mov_b32 v4, 8204
    v_mov_b32 v5, 1
    ds_write_b32 v4, v5
    s_branch L_late_ld
L_bulk:
    v_lshlrev_b32 v6, 8, v3
    v_lshl_add_u32 v6, v2, 4, v6
    v_add_u32 v6, 4096, v6
    s_waitcnt vmcnt(7)
    global_load_dwordx4 a[16:19], v6, s[36:37] offset:0 nt
    s_waitcnt vmcnt(7)
    global_load_dwordx4 a[20:23], v6, s[36:37] offset:64 nt
    s_waitcnt vmcnt(7)
    global_load_dwordx4 a[24:27], v6, s[36:37] offset:128 nt
    s_waitcnt vmcnt(7)
    global_load_dwordx4 a[28:31], v6, s[36:37] offset:192 nt
    v_add_u32 v6, 4096, v6
    s_waitcnt vmcnt(7)
    global_load_dwordx4 a[32:35], v6, s[36:37] offset:0 nt
    s_waitcnt vmcnt(7)
    global_load_dwordx4 a[36:39], v6, s[36:37] offset:64 nt
    s_waitcnt vmcnt(7)
    global_load_dwordx4 a[40:43], v6, s[36:37] offset:128 nt
    s_waitcnt vmcnt(7)
    global_load_dwordx4 a[44:47], v6, s[36:37] offset:192 nt
    v_add_u32 v6, 4096, v6
    s_waitcnt vmcnt(7)
    global_load_dwordx4 a[48:51], v6, s[36:37] offset:0 nt
    s_waitcnt vmcnt(7)
    global_load_dwordx4 a[52:55], v6, s[36:37] offset:64 nt
    s_waitcnt vmcnt(7)
    global_load_dwordx4 a[56:59], v6, s[36:37] offset:128 nt
    s_waitcnt vmcnt(7)
    global_load_dwordx4 a[60:63], v6, s[36:37] offset:192 nt
L_vld:
    v_lshlrev_b32 v6, 10, v2
    v_lshl_add_u32 v6, v3, 4, v6
    v_add_u32 v6, 0x1000, v6
    s_waitcnt vmcnt(7)
    global_load_dwordx4 v[88:91], v6, s[38:39] offset:-4096 nt
    s_waitcnt vmcnt(7)
    global_load_dwordx4 v[92:95], v6, s[38:39] offset:-3840 nt
    s_waitcnt vmcnt(7)
    global_load_dwordx4 v[96:99], v6, s[38:39] offset:-3584 nt
    s_waitcnt vmcnt(7)
    global_load_dwordx4 v[100:103], v6, s[38:39] offset:-3328 nt
    s_waitcnt vmcnt(7)
    global_load_dwordx4 v[104:107], v6, s[38:39] offset:0 nt
    s_waitcnt vmcnt(7)
    global_load_dwordx4 v[108:111], v6, s[38:39] offset:256 nt
    s_waitcnt vmcnt(7)
    global_load_dwordx4 v[112:115], v6, s[38:39] offset:512 nt
    s_waitcnt vmcnt(7)
    global_load_dwordx4 v[116:119], v6, s[38:39] offset:768 nt
    v_add_u32 v6, 0x2000, v6
    s_waitcnt vmcnt(7)
    global_load_dwordx4 v[120:123], v6, s[38:39] offset:-4096 nt
    s_waitcnt vmcnt(7)
    global_load_dwordx4 v[124:127], v6, s[38:39] offset:-3840 nt
    s_waitcnt vmcnt(7)
    global_load_dwordx4 v[128:131], v6, s[38:39] offset:-3584 nt
    s_waitcnt vmcnt(7)
    global_load_dwordx4 v[132:135], v6, s[38:39] offset:-3328 nt
    s_waitcnt vmcnt(7)
    global_load_dwordx4 v[136:139], v6, s[38:39] offset:0 nt
    s_waitcnt vmcnt(7)
    global_load_dwordx4 v[140:143], v6, s[38:39] offset:256 nt
    s_waitcnt vmcnt(7)
    global_load_dwordx4 v[144:147], v6, s[38:39] offset:512 nt
    s_waitcnt vmcnt(7)
    global_load_dwordx4 v[148:151], v6, s[38:39] offset:768 nt
    v_mov_b32 v4, 8208
    v_mov_b32 v5, 1
    s_mov_b64 exec, 1
    ds_add_u32 v4, v5
    s_mov_b64 exec, -1
L_late_ld:
    s_mov_b32 s62, 0
    v_mov_b32 v4, 8200
L_fl_7:
    ds_read_b32 v5, v4
    s_waitcnt lgkmcnt(0)
    v_readfirstlane_b32 s44, v5
    s_cmp_lg_u32 s44, 0
    s_cbranch_scc1 L_fld_8
    s_add_u32 s62, s62, 1
    s_cmp_ge_u32 s62, 4000000
    s_cbranch_scc1 L_fld_8
    s_sleep 1
    s_branch L_fl_7
L_fld_8:
    v_and_b32 v4, 7, v3
    v_mul_u32_u24 v4, 272, v4
    v_lshl_add_u32 v4, v2, 4, v4
    ds_read_b128 v[152:155], v4 offset:8448
    ds_read_b128 v[156:159], v4 offset:8512
    ds_read_b128 v[160:163], v4 offset:8576
    ds_read_b128 v[164:167], v4 offset:8640
    s_waitcnt vmcnt(16) lgkmcnt(0)
    v_mfma_f32_16x16x32_bf16 v[168:171], a[0:3], v[152:155], 0
    v_mfma_f32_16x16x32_bf16 v[168:171], a[4:7], v[156:159], v[168:171]
    v_mfma_f32_16x16x32_bf16 v[168:171], a[8:11], v[160:163], v[168:171]
    v_mfma_f32_16x16x32_bf16 v[168:171], a[12:15], v[164:167], v[168:171]
    v_mfma_f32_16x16x32_bf16 v[172:175], a[16:19], v[152:155], 0
    v_mfma_f32_16x16x32_bf16 v[172:175], a[20:23], v[156:159], v[172:175]
    v_mfma_f32_16x16x32_bf16 v[172:175], a[24:27], v[160:163], v[172:175]
    v_mfma_f32_16x16x32_bf16 v[172:175], a[28:31], v[164:167], v[172:175]
    v_mfma_f32_16x16x32_bf16 v[176:179], a[32:35], v[152:155], 0
    v_mfma_f32_16x16x32_bf16 v[176:179], a[36:39], v[156:159], v[176:179]
    v_mfma_f32_16x16x32_bf16 v[176:179], a[40:43], v[160:163], v[176:179]
    v_mfma_f32_16x16x32_bf16 v[176:179], a[44:47], v[164:167], v[176:179]
    v_mfma_f32_16x16x32_bf16 v[180:183], a[48:51], v[152:155], 0
    v_mfma_f32_16x16x32_bf16 v[180:183], a[52:55], v[156:159], v[180:183]
    v_mfma_f32_16x16x32_bf16 v[180:183], a[56:59], v[160:163], v[180:183]
    v_mfma_f32_16x16x32_bf16 v[180:183], a[60:63], v[164:167], v[180:183]
    s_nop 7
    s_mov_b32 s44, 0x3db504f3
    v_cvt_pk_bf16_f32 v4, v168, v169
    v_lshlrev_b32 v5, 16, v4
    v_and_b32 v6, 0xffff0000, v4
    v_mul_f32 v5, s44, v5
    v_mul_f32 v6, s44, v6
    v_cvt_pk_bf16_f32 v4, v5, v6
    v_lshlrev_b32 v168, 16, v4
    v_and_b32 v169, 0xffff0000, v4
    v_cvt_pk_bf16_f32 v4, v170, v171
    v_lshlrev_b32 v5, 16, v4
    v_and_b32 v6, 0xffff0000, v4
    v_mul_f32 v5, s44, v5
    v_mul_f32 v6, s44, v6
    v_cvt_pk_bf16_f32 v4, v5, v6
    v_lshlrev_b32 v170, 16, v4
    v_and_b32 v171, 0xffff0000, v4
    v_cvt_pk_bf16_f32 v4, v172, v173
    v_lshlrev_b32 v5, 16, v4
    v_and_b32 v6, 0xffff0000, v4
    v_mul_f32 v5, s44, v5
    v_mul_f32 v6, s44, v6
    v_cvt_pk_bf16_f32 v4, v5, v6
    v_lshlrev_b32 v172, 16, v4
    v_and_b32 v173, 0xffff0000, v4
    v_cvt_pk_bf16_f32 v4, v174, v175
    v_lshlrev_b32 v5, 16, v4
    v_and_b32 v6, 0xffff0000, v4
    v_mul_f32 v5, s44, v5
    v_mul_f32 v6, s44, v6
    v_cvt_pk_bf16_f32 v4, v5, v6
    v_lshlrev_b32 v174, 16, v4
    v_and_b32 v175, 0xffff0000, v4
    v_cvt_pk_bf16_f32 v4, v176, v177
    v_lshlrev_b32 v5, 16, v4
    v_and_b32 v6, 0xffff0000, v4
    v_mul_f32 v5, s44, v5
    v_mul_f32 v6, s44, v6
    v_cvt_pk_bf16_f32 v4, v5, v6
    v_lshlrev_b32 v176, 16, v4
    v_and_b32 v177, 0xffff0000, v4
    v_cvt_pk_bf16_f32 v4, v178, v179
    v_lshlrev_b32 v5, 16, v4
    v_and_b32 v6, 0xffff0000, v4
    v_mul_f32 v5, s44, v5
    v_mul_f32 v6, s44, v6
    v_cvt_pk_bf16_f32 v4, v5, v6
    v_lshlrev_b32 v178, 16, v4
    v_and_b32 v179, 0xffff0000, v4
    v_cvt_pk_bf16_f32 v4, v180, v181
    v_lshlrev_b32 v5, 16, v4
    v_and_b32 v6, 0xffff0000, v4
    v_mul_f32 v5, s44, v5
    v_mul_f32 v6, s44, v6
    v_cvt_pk_bf16_f32 v4, v5, v6
    v_lshlrev_b32 v180, 16, v4
    v_and_b32 v181, 0xffff0000, v4
    v_cvt_pk_bf16_f32 v4, v182, v183
    v_lshlrev_b32 v5, 16, v4
    v_and_b32 v6, 0xffff0000, v4
    v_mul_f32 v5, s44, v5
    v_mul_f32 v6, s44, v6
    v_cvt_pk_bf16_f32 v4, v5, v6
    v_lshlrev_b32 v182, 16, v4
    v_and_b32 v183, 0xffff0000, v4
    v_max3_f32 v8, v168, v169, v170
    v_max3_f32 v8, v8, v171, v172
    v_max3_f32 v8, v8, v173, v174
    v_max3_f32 v8, v8, v175, v176
    v_max3_f32 v8, v8, v177, v178
    v_max3_f32 v8, v8, v179, v180
    v_max3_f32 v8, v8, v181, v182
    v_max_f32 v8, v8, v183
    v_mov_b32 v5, v8
    s_nop 1
    v_permlane16_swap_b32 v8, v5
    s_nop 1
    v_max_f32 v8, v8, v5
    v_mov_b32 v5, v8
    s_nop 1
    v_permlane32_swap_b32 v8, v5
    s_nop 1
    v_max_f32 v8, v8, v5
    s_mov_b32 s44, 0x3fb8aa3b
    v_mul_f32 v5, s44, v8
    v_fma_f32 v168, v168, s44, -v5
    v_exp_f32 v168, v168
    v_fma_f32 v169, v169, s44, -v5
    v_exp_f32 v169, v169
    v_fma_f32 v170, v170, s44, -v5
    v_exp_f32 v170, v170
    v_fma_f32 v171, v171, s44, -v5
    v_exp_f32 v171, v171
    v_fma_f32 v172, v172, s44, -v5
    v_exp_f32 v172, v172
    v_fma_f32 v173, v173, s44, -v5
    v_exp_f32 v173, v173
    v_fma_f32 v174, v174, s44, -v5
    v_exp_f32 v174, v174
    v_fma_f32 v175, v175, s44, -v5
    v_exp_f32 v175, v175
    v_fma_f32 v176, v176, s44, -v5
    v_exp_f32 v176, v176
    v_fma_f32 v177, v177, s44, -v5
    v_exp_f32 v177, v177
    v_fma_f32 v178, v178, s44, -v5
    v_exp_f32 v178, v178
    v_fma_f32 v179, v179, s44, -v5
    v_exp_f32 v179, v179
    v_fma_f32 v180, v180, s44, -v5
    v_exp_f32 v180, v180
    v_fma_f32 v181, v181, s44, -v5
    v_exp_f32 v181, v181
    v_fma_f32 v182, v182, s44, -v5
    v_exp_f32 v182, v182
    v_fma_f32 v183, v183, s44, -v5
    v_exp_f32 v183, v183
    s_nop 0
    v_add_f32 v9, v168, v169
    v_add_f32 v9, v9, v170
    v_add_f32 v9, v9, v171
    v_add_f32 v9, v9, v172
    v_add_f32 v9, v9, v173
    v_add_f32 v9, v9, v174
    v_add_f32 v9, v9, v175
    v_add_f32 v9, v9, v176
    v_add_f32 v9, v9, v177
    v_add_f32 v9, v9, v178
    v_add_f32 v9, v9, v179
    v_add_f32 v9, v9, v180
    v_add_f32 v9, v9, v181
    v_add_f32 v9, v9, v182
    v_add_f32 v9, v9, v183
    v_mov_b32 v5, v9
    s_nop 1
    v_permlane16_swap_b32 v9, v5
    s_nop 1
    v_add_f32 v9, v9, v5
    v_mov_b32 v5, v9
    s_nop 1
    v_permlane32_swap_b32 v9, v5
    s_nop 1
    v_add_f32 v9, v9, v5
    v_cvt_pk_bf16_f32 v12, v168, v169
    v_cvt_pk_bf16_f32 v13, v170, v171
    v_cvt_pk_bf16_f32 v14, v172, v173
    v_cvt_pk_bf16_f32 v15, v174, v175
    v_cvt_pk_bf16_f32 v16, v176, v177
    v_cvt_pk_bf16_f32 v17, v178, v179
    v_cvt_pk_bf16_f32 v18, v180, v181
    v_cvt_pk_bf16_f32 v19, v182, v183
    s_waitcnt vmcnt(8)
    v_perm_b32 v152, v92, v88, s30
    v_perm_b32 v153, v100, v96, s30
    v_perm_b32 v154, v108, v104, s30
    v_perm_b32 v155, v116, v112, s30
    v_perm_b32 v156, v92, v88, s31
    v_perm_b32 v157, v100, v96, s31
    v_perm_b32 v158, v108, v104, s31
    v_perm_b32 v159, v116, v112, s31
    v_perm_b32 v160, v93, v89, s30
    v_perm_b32 v161, v101, v97, s30
    v_perm_b32 v162, v109, v105, s30
    v_perm_b32 v163, v117, v113, s30
    v_perm_b32 v164, v93, v89, s31
    v_perm_b32 v165, v101, v97, s31
    v_perm_b32 v166, v109, v105, s31
    v_perm_b32 v167, v117, v113, s31
    v_perm_b32 v168, v94, v90, s30
    v_perm_b32 v169, v102, v98, s30
    v_perm_b32 v170, v110, v106, s30
    v_perm_b32 v171, v118, v114, s30
    v_perm_b32 v172, v94, v90, s31
    v_perm_b32 v173, v102, v98, s31
    v_perm_b32 v174, v110, v106, s31
    v_perm_b32 v175, v118, v114, s31
    v_perm_b32 v176, v95, v91, s30
    v_perm_b32 v177, v103, v99, s30
    v_perm_b32 v178, v111, v107, s30
    v_perm_b32 v179, v119, v115, s30
    v_perm_b32 v180, v95, v91, s31
    v_perm_b32 v181, v103, v99, s31
    v_perm_b32 v182, v111, v107, s31
    v_perm_b32 v183, v119, v115, s31
    s_nop 1
    v_mfma_f32_16x16x32_bf16 a[0:3], v[12:15], v[152:155], 0
    v_mfma_f32_16x16x32_bf16 a[4:7], v[12:15], v[156:159], 0
    v_mfma_f32_16x16x32_bf16 a[8:11], v[12:15], v[160:163], 0
    v_mfma_f32_16x16x32_bf16 a[12:15], v[12:15], v[164:167], 0
    v_mfma_f32_16x16x32_bf16 a[16:19], v[12:15], v[168:171], 0
    v_mfma_f32_16x16x32_bf16 a[20:23], v[12:15], v[172:175], 0
    v_mfma_f32_16x16x32_bf16 a[24:27], v[12:15], v[176:179], 0
    v_mfma_f32_16x16x32_bf16 a[28:31], v[12:15], v[180:183], 0
    s_waitcnt vmcnt(0)
    v_perm_b32 v152, v124, v120, s30
    v_perm_b32 v153, v132, v128, s30
    v_perm_b32 v154, v140, v136, s30
    v_perm_b32 v155, v148, v144, s30
    v_perm_b32 v156, v124, v120, s31
    v_perm_b32 v157, v132, v128, s31
    v_perm_b32 v158, v140, v136, s31
    v_perm_b32 v159, v148, v144, s31
    v_perm_b32 v160, v125, v121, s30
    v_perm_b32 v161, v133, v129, s30
    v_perm_b32 v162, v141, v137, s30
    v_perm_b32 v163, v149, v145, s30
    v_perm_b32 v164, v125, v121, s31
    v_perm_b32 v165, v133, v129, s31
    v_perm_b32 v166, v141, v137, s31
    v_perm_b32 v167, v149, v145, s31
    v_perm_b32 v168, v126, v122, s30
    v_perm_b32 v169, v134, v130, s30
    v_perm_b32 v170, v142, v138, s30
    v_perm_b32 v171, v150, v146, s30
    v_perm_b32 v172, v126, v122, s31
    v_perm_b32 v173, v134, v130, s31
    v_perm_b32 v174, v142, v138, s31
    v_perm_b32 v175, v150, v146, s31
    v_perm_b32 v176, v127, v123, s30
    v_perm_b32 v177, v135, v131, s30
    v_perm_b32 v178, v143, v139, s30
    v_perm_b32 v179, v151, v147, s30
    v_perm_b32 v180, v127, v123, s31
    v_perm_b32 v181, v135, v131, s31
    v_perm_b32 v182, v143, v139, s31
    v_perm_b32 v183, v151, v147, s31
    s_nop 1
    v_mfma_f32_16x16x32_bf16 a[0:3], v[16:19], v[152:155], a[0:3]
    v_mfma_f32_16x16x32_bf16 a[4:7], v[16:19], v[156:159], a[4:7]
    v_mfma_f32_16x16x32_bf16 a[8:11], v[16:19], v[160:163], a[8:11]
    v_mfma_f32_16x16x32_bf16 a[12:15], v[16:19], v[164:167], a[12:15]
    v_mfma_f32_16x16x32_bf16 a[16:19], v[16:19], v[168:171], a[16:19]
    v_mfma_f32_16x16x32_bf16 a[20:23], v[16:19], v[172:175], a[20:23]
    v_mfma_f32_16x16x32_bf16 a[24:27], v[16:19], v[176:179], a[24:27]
    v_mfma_f32_16x16x32_bf16 a[28:31], v[16:19], v[180:183], a[28:31]
    s_mov_b32 s62, 0
    v_mov_b32 v4, 8208
L_cs_9:
    ds_read_b32 v5, v4
    s_waitcnt lgkmcnt(0)
    v_readfirstlane_b32 s44, v5
    s_cmp_ge_u32 s44, 8
    s_cbranch_scc1 L_csd_10
    s_add_u32 s62, s62, 1
    s_cmp_ge_u32 s62, 4000000
    s_cbranch_scc1 L_csd_10
    s_sleep 1
    s_branch L_cs_9
L_csd_10:
    s_cmp_ge_u32 s28, 4
    s_cselect_b32 s44, 1, 0
    s_cmp_lt_u32 s2, 224
    s_cselect_b32 s45, 1, 0
    s_and_b32 s57, s44, s45
    s_cmp_lt_u32 s28, 4
    s_cbranch_scc1 L_llo_11
    s_cmp_lg_u32 s57, 0
    s_cselect_b64 exec, -1, 0
    v_mul_u32_u24 v5, 16384, v2
    v_lshl_add_u32 v5, v3, 4, v5
    global_load_dwordx4 v[56:59], v5, s[40:41] nt
    v_add_u32 v5, 2048, v5
    global_load_dwordx4 v[60:63], v5, s[40:41] nt
    v_add_u32 v5, 2048, v5
    global_load_dwordx4 v[64:67], v5, s[40:41] nt
    v_add_u32 v5, 2048, v5
    global_load_dwordx4 v[68:71], v5, s[40:41] nt
    v_add_u32 v5, 2048, v5
    global_load_dwordx4 v[72:75], v5, s[40:41] nt
    v_add_u32 v5, 2048, v5
    global_load_dwordx4 v[76:79], v5, s[40:41] nt
    v_add_u32 v5, 2048, v5
    global_load_dwordx4 v[80:83], v5, s[40:41] nt
    v_add_u32 v5, 2048, v5
    global_load_dwordx4 v[84:87], v5, s[40:41] nt
    s_mov_b64 exec, -1
    s_branch L_lld_12
L_llo_11:
    v_mul_u32_u24 v4, 16384, v2
    v_lshl_add_u32 v4, v3, 4, v4
    global_load_dwordx4 v[24:27], v4, s[42:43] nt
    v_add_u32 v4, 2048, v4
    global_load_dwordx4 v[28:31], v4, s[42:43] nt
    v_add_u32 v4, 2048, v4
    global_load_dwordx4 v[32:35], v4, s[42:43] nt
    v_add_u32 v4, 2048, v4
    global_load_dwordx4 v[36:39], v4, s[42:43] nt
    v_add_u32 v4, 2048, v4
    global_load_dwordx4 v[40:43], v4, s[42:43] nt
    v_add_u32 v4, 2048, v4
    global_load_dwordx4 v[44:47], v4, s[42:43] nt
    v_add_u32 v4, 2048, v4
    global_load_dwordx4 v[48:51], v4, s[42:43] nt
    v_add_u32 v4, 2048, v4
    global_load_dwordx4 v[52:55], v4, s[42:43] nt
L_lld_12:
    s_lshl_b32 s44, s28, 6
    v_lshlrev_b32 v4, 3, v1
    v_add_u32 v4, s44, v4
    s_mov_b64 exec, 0xff
    ds_write_b64 v4, v[8:9] offset:11776
    s_mov_b64 exec, -1
    s_lshl_b32 s44, s28, 12
    s_add_u32 s44, s44, 69632
    v_lshlrev_b32 v7, 5, v3
    v_lshl_add_u32 v7, v2, 11, v7
    v_add_u32 v7, s44, v7
    s_nop 7
    v_accvgpr_read_b32 v152, a0
    v_accvgpr_read_b32 v153, a4
    v_accvgpr_read_b32 v154, a8
    v_accvgpr_read_b32 v155, a12
    v_accvgpr_read_b32 v156, a16
    v_accvgpr_read_b32 v157, a20
    v_accvgpr_read_b32 v158, a24
    v_accvgpr_read_b32 v159, a28
    v_accvgpr_read_b32 v160, a1
    v_accvgpr_read_b32 v161, a5
    v_accvgpr_read_b32 v162, a9
    v_accvgpr_read_b32 v163, a13
    v_accvgpr_read_b32 v164, a17
    v_accvgpr_read_b32 v165, a21
    v_accvgpr_read_b32 v166, a25
    v_accvgpr_read_b32 v167, a29
    v_accvgpr_read_b32 v168, a2
    v_accvgpr_read_b32 v169, a6
    v_accvgpr_read_b32 v170, a10
    v_accvgpr_read_b32 v171, a14
    v_accvgpr_read_b32 v172, a18
    v_accvgpr_read_b32 v173, a22
    v_accvgpr_read_b32 v174, a26
    v_accvgpr_read_b32 v175, a30
    v_accvgpr_read_b32 v176, a3
    v_accvgpr_read_b32 v177, a7
    v_accvgpr_read_b32 v178, a11
    v_accvgpr_read_b32 v179, a15
    v_accvgpr_read_b32 v180, a19
    v_accvgpr_read_b32 v181, a23
    v_accvgpr_read_b32 v182, a27
    v_accvgpr_read_b32 v183, a31
    s_mov_b32 exec_lo, 0xffffffff
    s_mov_b32 exec_hi, 0
    ds_write_b128 v7, v[152:155] offset:0
    ds_write_b128 v7, v[156:159] offset:16
    ds_write_b128 v7, v[160:163] offset:512
    ds_write_b128 v7, v[164:167] offset:528
    ds_write_b128 v7, v[168:171] offset:1024
    ds_write_b128 v7, v[172:175] offset:1040
    ds_write_b128 v7, v[176:179] offset:1536
    ds_write_b128 v7, v[180:183] offset:1552
    s_mov_b64 exec, -1
    s_waitcnt lgkmcnt(0)
    s_barrier
    s_lshl_b32 s44, s28, 3
    v_mov_b32 v4, s44
    ds_read_b64 v[152:153], v4 offset:11776
    ds_read_b64 v[154:155], v4 offset:11840
    ds_read_b64 v[156:157], v4 offset:11904
    ds_read_b64 v[158:159], v4 offset:11968
    ds_read_b64 v[160:161], v4 offset:12032
    ds_read_b64 v[162:163], v4 offset:12096
    ds_read_b64 v[164:165], v4 offset:12160
    ds_read_b64 v[166:167], v4 offset:12224
    s_lshl_b32 s44, s28, 9
    s_add_u32 s44, s44, 69632
    v_and_b32 v6, 31, v1
    v_lshlrev_b32 v6, 4, v6
    v_add_u32 v5, s44, v6
    ds_read_b128 v[88:91], v5 offset:0
    ds_read_b128 v[92:95], v5 offset:4096
    ds_read_b128 v[96:99], v5 offset:8192
    ds_read_b128 v[100:103], v5 offset:12288
    ds_read_b128 v[104:107], v5 offset:16384
    ds_read_b128 v[108:111], v5 offset:20480
    ds_read_b128 v[112:115], v5 offset:24576
    ds_read_b128 v[116:119], v5 offset:28672
    s_bfe_u32 s44, s2, 0x20004
    s_lshl_b32 s44, s44, 3
    s_add_u32 s44, s44, s28
    s_lshr_b32 s45, s2, 6
    s_and_b32 s46, s2, 15
    s_lshl_b32 s54, s44, 15
    s_lshl_b32 s55, s45, 12
    s_add_u32 s54, s54, s55
    s_lshl_b32 s55, s46, 8
    s_add_u32 s54, s54, s55
    s_add_u32 s54, s54, 2097152
    v_bfe_u32 v7, v1, 4, 1
    v_lshlrev_b32 v7, 14, v7
    v_lshl_add_u32 v7, v3, 4, v7
    v_add_u32 v168, s54, v7
    s_lshl_b32 s44, s44, 2
    s_add_u32 s44, s44, s45
    s_lshl_b32 s44, s44, 8
    s_lshl_b32 s46, s46, 4
    s_add_u32 s44, s44, s46
    s_add_u32 s44, s44, 4194304
    v_mov_b32 v169, s44
    s_waitcnt lgkmcnt(0)
    v_max3_f32 v8, v152, v154, v156
    v_max3_f32 v8, v8, v158, v160
    v_max3_f32 v8, v8, v162, v164
    v_max_f32 v8, v8, v166
    s_mov_b32 s46, 0x3fb8aa3b
    v_sub_f32 v152, v152, v8
    v_mul_f32 v152, s46, v152
    v_exp_f32 v152, v152
    v_sub_f32 v154, v154, v8
    v_mul_f32 v154, s46, v154
    v_exp_f32 v154, v154
    v_sub_f32 v156, v156, v8
    v_mul_f32 v156, s46, v156
    v_exp_f32 v156, v156
    v_sub_f32 v158, v158, v8
    v_mul_f32 v158, s46, v158
    v_exp_f32 v158, v158
    v_sub_f32 v160, v160, v8
    v_mul_f32 v160, s46, v160
    v_exp_f32 v160, v160
    v_sub_f32 v162, v162, v8
    v_mul_f32 v162, s46, v162
    v_exp_f32 v162, v162
    v_sub_f32 v164, v164, v8
    v_mul_f32 v164, s46, v164
    v_exp_f32 v164, v164
    v_sub_f32 v166, v166, v8
    v_mul_f32 v166, s46, v166
    v_exp_f32 v166, v166
    s_nop 0
    v_mul_f32 v4, v152, v88
    v_mul_f32 v5, v152, v89
    v_mul_f32 v6, v152, v90
    v_mul_f32 v7, v152, v91
    v_mul_f32 v9, v152, v153
    v_fmac_f32 v4, v154, v92
    v_fmac_f32 v5, v154, v93
    v_fmac_f32 v6, v154, v94
    v_fmac_f32 v7, v154, v95
    v_fmac_f32 v9, v154, v155
    v_fmac_f32 v4, v156, v96
    v_fmac_f32 v5, v156, v97
    v_fmac_f32 v6, v156, v98
    v_fmac_f32 v7, v156, v99
    v_fmac_f32 v9, v156, v157
    v_fmac_f32 v4, v158, v100
    v_fmac_f32 v5, v158, v101
    v_fmac_f32 v6, v158, v102
    v_fmac_f32 v7, v158, v103
    v_fmac_f32 v9, v158, v159
    v_fmac_f32 v4, v160, v104
    v_fmac_f32 v5, v160, v105
    v_fmac_f32 v6, v160, v106
    v_fmac_f32 v7, v160, v107
    v_fmac_f32 v9, v160, v161
    v_fmac_f32 v4, v162, v108
    v_fmac_f32 v5, v162, v109
    v_fmac_f32 v6, v162, v110
    v_fmac_f32 v7, v162, v111
    v_fmac_f32 v9, v162, v163
    v_fmac_f32 v4, v164, v112
    v_fmac_f32 v5, v164, v113
    v_fmac_f32 v6, v164, v114
    v_fmac_f32 v7, v164, v115
    v_fmac_f32 v9, v164, v165
    v_fmac_f32 v4, v166, v116
    v_fmac_f32 v5, v166, v117
    v_fmac_f32 v6, v166, v118
    v_fmac_f32 v7, v166, v119
    v_fmac_f32 v9, v166, v167
    v_mov_b32 v10, v8
    v_mov_b32 v11, v9
    v_bfi_b32 v4, v184, s96, v4
    v_bfi_b32 v5, v184, s97, v5
    v_bfi_b32 v6, v184, s98, v6
    v_bfi_b32 v7, v184, s99, v7
    v_bfi_b32 v8, v184, s96, v8
    v_bfi_b32 v9, v184, s97, v9
    v_bfi_b32 v10, v184, s98, v10
    v_bfi_b32 v11, v184, s99, v11
    s_mov_b32 exec_hi, 0
    global_store_dwordx4 v168, v[4:7], s[26:27] sc1
    s_mov_b64 exec, 1
    global_store_dwordx4 v169, v[8:11], s[26:27] sc1
    s_mov_b64 exec, -1
    s_cmp_eq_u32 s57, 0
    s_cbranch_scc1 L_nodown
    s_mov_b32 s62, 0
    v_mov_b32 v4, 8204
L_fl_13:
    ds_read_b32 v5, v4
    s_waitcnt lgkmcnt(0)
    v_readfirstlane_b32 s44, v5
    s_cmp_lg_u32 s44, 0
    s_cbranch_scc1 L_fld_14
    s_add_u32 s62, s62, 1
    s_cmp_ge_u32 s62, 4000000
    s_cbranch_scc1 L_fld_14
    s_sleep 1
    s_branch L_fl_13
L_fld_14:
    s_lshr_b32 s44, s28, 1
    s_and_b32 s44, s44, 1
    s_lshl_b32 s44, s44, 6
    v_and_b32 v4, 3, v3
    v_lshlrev_b32 v4, 7, v4
    v_lshl_add_u32 v4, v2, 4, v4
    v_add_u32 v4, s44, v4
    ds_read_b128 v[20:23], v4 offset:10752
    s_waitcnt vmcnt(2) lgkmcnt(0)
    v_perm_b32 v152, v60, v56, s30
    v_perm_b32 v153, v68, v64, s30
    v_perm_b32 v154, v76, v72, s30
    v_perm_b32 v155, v84, v80, s30
    v_perm_b32 v156, v60, v56, s31
    v_perm_b32 v157, v68, v64, s31
    v_perm_b32 v158, v76, v72, s31
    v_perm_b32 v159, v84, v80, s31
    v_perm_b32 v160, v61, v57, s30
    v_perm_b32 v161, v69, v65, s30
    v_perm_b32 v162, v77, v73, s30
    v_perm_b32 v163, v85, v81, s30
    v_perm_b32 v164, v61, v57, s31
    v_perm_b32 v165, v69, v65, s31
    v_perm_b32 v166, v77, v73, s31
    v_perm_b32 v167, v85, v81, s31
    v_perm_b32 v168, v62, v58, s30
    v_perm_b32 v169, v70, v66, s30
    v_perm_b32 v170, v78, v74, s30
    v_perm_b32 v171, v86, v82, s30
    v_perm_b32 v172, v62, v58, s31
    v_perm_b32 v173, v70, v66, s31
    v_perm_b32 v174, v78, v74, s31
    v_perm_b32 v175, v86, v82, s31
    v_perm_b32 v176, v63, v59, s30
    v_perm_b32 v177, v71, v67, s30
    v_perm_b32 v178, v79, v75, s30
    v_perm_b32 v179, v87, v83, s30
    v_perm_b32 v180, v63, v59, s31
    v_perm_b32 v181, v71, v67, s31
    v_perm_b32 v182, v79, v75, s31
    v_perm_b32 v183, v87, v83, s31
    s_nop 1
    v_mfma_f32_16x16x32_bf16 v[56:59], v[20:23], v[152:155], 0
    v_mfma_f32_16x16x32_bf16 v[60:63], v[20:23], v[156:159], 0
    v_mfma_f32_16x16x32_bf16 v[64:67], v[20:23], v[160:163], 0
    v_mfma_f32_16x16x32_bf16 v[68:71], v[20:23], v[164:167], 0
    v_mfma_f32_16x16x32_bf16 v[72:75], v[20:23], v[168:171], 0
    v_mfma_f32_16x16x32_bf16 v[76:79], v[20:23], v[172:175], 0
    v_mfma_f32_16x16x32_bf16 v[80:83], v[20:23], v[176:179], 0
    v_mfma_f32_16x16x32_bf16 v[84:87], v[20:23], v[180:183], 0
    s_sub_u32 s44, s28, 4
    s_lshl_b32 s44, s44, 11
    s_add_u32 s44, s44, 45056
    v_lshlrev_b32 v7, 5, v3
    v_add_u32 v7, s44, v7
    s_nop 7
    v_mov_b32 v152, v56
    v_mov_b32 v153, v60
    v_mov_b32 v154, v64
    v_mov_b32 v155, v68
    v_mov_b32 v156, v72
    v_mov_b32 v157, v76
    v_mov_b32 v158, v80
    v_mov_b32 v159, v84
    v_mov_b32 v160, v57
    v_mov_b32 v161, v61
    v_mov_b32 v162, v65
    v_mov_b32 v163, v69
    v_mov_b32 v164, v73
    v_mov_b32 v165, v77
    v_mov_b32 v166, v81
    v_mov_b32 v167, v85
    v_mov_b32 v168, v58
    v_mov_b32 v169, v62
    v_mov_b32 v170, v66
    v_mov_b32 v171, v70
    v_mov_b32 v172, v74
    v_mov_b32 v173, v78
    v_mov_b32 v174, v82
    v_mov_b32 v175, v86
    v_mov_b32 v176, v59
    v_mov_b32 v177, v63
    v_mov_b32 v178, v67
    v_mov_b32 v179, v71
    v_mov_b32 v180, v75
    v_mov_b32 v181, v79
    v_mov_b32 v182, v83
    v_mov_b32 v183, v87
    s_mov_b32 exec_lo, 0xffff
    s_mov_b32 exec_hi, 0
    ds_write_b128 v7, v[152:155] offset:0
    ds_write_b128 v7, v[156:159] offset:16
    ds_write_b128 v7, v[160:163] offset:512
    ds_write_b128 v7, v[164:167] offset:528
    ds_write_b128 v7, v[168:171] offset:1024
    ds_write_b128 v7, v[172:175] offset:1040
    ds_write_b128 v7, v[176:179] offset:1536
    ds_write_b128 v7, v[180:183] offset:1552
    s_mov_b64 exec, -1
L_nodown:
    s_cmp_ge_u32 s28, 4
    s_cbranch_scc1 L_nowog
    s_lshr_b32 s45, s2, 3
    s_lshl_b32 s44, s45, 15
    s_bfe_u32 s46, s2, 0x10002
    s_lshl_b32 s46, s46, 14
    s_add_u32 s44, s44, s46
    s_lshl_b32 s46, s28, 12
    s_add_u32 s44, s44, s46
    s_bfe_u32 s46, s2, 0x10001
    s_lshl_b32 s46, s46, 7
    s_add_u32 s44, s44, s46
    s_add_u32 s44, s44, 2097152
    v_lshrrev_b32 v6, 3, v1
    v_and_b32 v7, 7, v1
    v_lshlrev_b32 v4, 8, v6
    v_lshl_add_u32 v4, v7, 4, v4
    v_add_u32 v4, s44, v4
    s_lshl_b32 s44, s45, 2
    s_add_u32 s44, s44, s28
    s_lshl_b32 s44, s44, 8
    s_add_u32 s44, s44, 4194304
    v_lshlrev_b32 v5, 4, v6
    v_add_u32 v5, s44, v5
    s_waitcnt vmcnt(0)
    v_perm_b32 v152, v28, v24, s30
    v_perm_b32 v153, v36, v32, s30
    v_perm_b32 v154, v44, v40, s30
    v_perm_b32 v155, v52, v48, s30
    v_perm_b32 v156, v28, v24, s31
    v_perm_b32 v157, v36, v32, s31
    v_perm_b32 v158, v44, v40, s31
    v_perm_b32 v159, v52, v48, s31
    v_perm_b32 v160, v29, v25, s30
    v_perm_b32 v161, v37, v33, s30
    v_perm_b32 v162, v45, v41, s30
    v_perm_b32 v163, v53, v49, s30
    v_perm_b32 v164, v29, v25, s31
    v_perm_b32 v165, v37, v33, s31
    v_perm_b32 v166, v45, v41, s31
    v_perm_b32 v167, v53, v49, s31
    v_perm_b32 v168, v30, v26, s30
    v_perm_b32 v169, v38, v34, s30
    v_perm_b32 v170, v46, v42, s30
    v_perm_b32 v171, v54, v50, s30
    v_perm_b32 v172, v30, v26, s31
    v_perm_b32 v173, v38, v34, s31
    v_perm_b32 v174, v46, v42, s31
    v_perm_b32 v175, v54, v50, s31
    v_perm_b32 v176, v31, v27, s30
    v_perm_b32 v177, v39, v35, s30
    v_perm_b32 v178, v47, v43, s30
    v_perm_b32 v179, v55, v51, s30
    v_perm_b32 v180, v31, v27, s31
    v_perm_b32 v181, v39, v35, s31
    v_perm_b32 v182, v47, v43, s31
    v_perm_b32 v183, v55, v51, s31
    s_mov_b32 s62, 0
L_spin_15:
    global_load_dwordx4 v[96:99], v5, s[26:27] sc1
    global_load_dwordx4 v[100:103], v5, s[26:27] offset:128 sc1
    global_load_dwordx4 v[88:91], v4, s[26:27] sc1
    global_load_dwordx4 v[92:95], v4, s[26:27] offset:2048 sc1
    s_waitcnt vmcnt(0)
    v_xor_b32 v8, s96, v96
    v_xor_b32 v10, s97, v97
    v_or_b32 v8, v8, v10
    v_xor_b32 v10, s98, v98
    v_xor_b32 v11, s99, v99
    v_or3_b32 v8, v8, v10, v11
    v_xor_b32 v10, s96, v100
    v_xor_b32 v11, s97, v101
    v_or3_b32 v8, v8, v10, v11
    v_xor_b32 v10, s98, v102
    v_xor_b32 v11, s99, v103
    v_or3_b32 v8, v8, v10, v11
    v_xor_b32 v10, s96, v88
    v_xor_b32 v11, s97, v89
    v_or3_b32 v8, v8, v10, v11
    v_xor_b32 v10, s98, v90
    v_xor_b32 v11, s99, v91
    v_or3_b32 v8, v8, v10, v11
    v_xor_b32 v10, s96, v92
    v_xor_b32 v11, s97, v93
    v_or3_b32 v8, v8, v10, v11
    v_xor_b32 v10, s98, v94
    v_xor_b32 v11, s99, v95
    v_or3_b32 v8, v8, v10, v11
    v_and_b32 v8, 0xff, v8
    v_cmp_ne_u32 vcc, 0, v8
    s_nop 1
    s_cbranch_vccz L_spun_16
    s_add_u32 s62, s62, 1
    s_cmp_ge_u32 s62, 200000
    s_cbranch_scc1 L_spun_16
    s_sleep 1
    s_branch L_spin_15
L_spun_16:
    v_and_b32 v88, 0xffffff00, v88
    v_and_b32 v89, 0xffffff00, v89
    v_and_b32 v90, 0xffffff00, v90
    v_and_b32 v91, 0xffffff00, v91
    v_and_b32 v92, 0xffffff00, v92
    v_and_b32 v93, 0xffffff00, v93
    v_and_b32 v94, 0xffffff00, v94
    v_and_b32 v95, 0xffffff00, v95
    v_and_b32 v96, 0xffffff00, v96
    v_and_b32 v97, 0xffffff00, v97
    v_and_b32 v98, 0xffffff00, v98
    v_and_b32 v99, 0xffffff00, v99
    v_and_b32 v100, 0xffffff00, v100
    v_and_b32 v101, 0xffffff00, v101
    v_and_b32 v102, 0xffffff00, v102
    v_and_b32 v103, 0xffffff00, v103
    v_max_f32 v8, v96, v100
    s_nop 1
    v_max_f32_dpp v8, v8, v8 row_ror:8 row_mask:0xf bank_mask:0xf
    v_mov_b32 v5, v8
    s_nop 1
    v_permlane16_swap_b32 v8, v5
    s_nop 1
    v_max_f32 v8, v8, v5
    v_mov_b32 v5, v8
    s_nop 1
    v_permlane32_swap_b32 v8, v5
    s_nop 1
    v_max_f32 v8, v8, v5
    s_mov_b32 s44, 0x3fb8aa3b
    v_sub_f32 v9, v96, v8
    v_sub_f32 v10, v100, v8
    v_mul_f32 v9, s44, v9
    v_mul_f32 v10, s44, v10
    v_exp_f32 v9, v9
    v_exp_f32 v10, v10
    s_nop 0
    v_mul_f32 v8, v9, v97
    v_fmac_f32 v8, v10, v101
    v_mul_f32 v104, v9, v88
    v_fmac_f32 v104, v10, v92
    v_mul_f32 v105, v9, v89
    v_fmac_f32 v105, v10, v93
    v_mul_f32 v106, v9, v90
    v_fmac_f32 v106, v10, v94
    v_mul_f32 v107, v9, v91
    v_fmac_f32 v107, v10, v95
    s_nop 1
    v_add_f32_dpp v8, v8, v8 row_ror:8 row_mask:0xf bank_mask:0xf
    v_add_f32_dpp v104, v104, v104 row_ror:8 row_mask:0xf bank_mask:0xf
    v_add_f32_dpp v105, v105, v105 row_ror:8 row_mask:0xf bank_mask:0xf
    v_add_f32_dpp v106, v106, v106 row_ror:8 row_mask:0xf bank_mask:0xf
    v_add_f32_dpp v107, v107, v107 row_ror:8 row_mask:0xf bank_mask:0xf
    v_mov_b32 v112, v8
    v_mov_b32 v113, v104
    v_mov_b32 v114, v105
    v_mov_b32 v115, v106
    v_mov_b32 v116, v107
    v_permlane16_swap_b32 v8, v112
    v_permlane16_swap_b32 v104, v113
    v_permlane16_swap_b32 v105, v114
    v_permlane16_swap_b32 v106, v115
    v_permlane16_swap_b32 v107, v116
    v_add_f32 v8, v8, v112
    v_add_f32 v104, v104, v113
    v_add_f32 v105, v105, v114
    v_add_f32 v106, v106, v115
    v_add_f32 v107, v107, v116
    v_mov_b32 v112, v8
    v_mov_b32 v113, v104
    v_mov_b32 v114, v105
    v_mov_b32 v115, v106
    v_mov_b32 v116, v107
    v_permlane32_swap_b32 v8, v112
    v_permlane32_swap_b32 v104, v113
    v_permlane32_swap_b32 v105, v114
    v_permlane32_swap_b32 v106, v115
    v_permlane32_swap_b32 v107, v116
    v_add_f32 v8, v8, v112
    v_add_f32 v104, v104, v113
    v_add_f32 v105, v105, v114
    v_add_f32 v106, v106, v115
    v_add_f32 v107, v107, v116
    v_rcp_f32 v10, v8
    s_nop 0
    v_fma_f32 v11, -v8, v10, 1.0
    v_fma_f32 v10, v11, v10, v10
    v_mul_f32 v104, v10, v104
    v_mul_f32 v105, v10, v105
    v_mul_f32 v106, v10, v106
    v_mul_f32 v107, v10, v107
    v_cvt_pk_bf16_f32 v8, v104, v105
    v_cvt_pk_bf16_f32 v9, v106, v107
    s_lshl_b32 s44, s28, 6
    v_lshlrev_b32 v4, 3, v7
    v_add_u32 v4, s44, v4
    s_mov_b64 exec, 0xff
    ds_write_b64 v4, v[8:9] offset:11264
    s_mov_b64 exec, -1
    v_and_b32 v4, 3, v3
    v_lshlrev_b32 v4, 6, v4
    v_lshl_add_u32 v4, v2, 4, v4
    s_lshl_b32 s44, s28, 11
    s_add_u32 s44, s44, 53248
    v_lshlrev_b32 v7, 5, v3
    v_add_u32 v7, s44, v7
    v_lshrrev_b32 v6, 5, v1
    v_lshlrev_b32 v6, 9, v6
    v_and_b32 v5, 31, v1
    v_lshl_add_u32 v6, v5, 4, v6
    v_add_u32 v6, s44, v6
    s_and_b32 s44, s2, 1
    s_lshl_b32 s44, s44, 18
    s_lshl_b32 s45, s28, 16
    s_add_u32 s44, s44, s45
    s_lshr_b32 s45, s2, 1
    s_lshl_b32 s45, s45, 6
    s_add_u32 s44, s44, s45
    s_add_u32 s44, s44, 5242880
    v_lshrrev_b32 v16, 2, v5
    v_lshlrev_b32 v16, 13, v16
    v_lshrrev_b32 v17, 5, v1
    v_lshl_add_u32 v16, v17, 19, v16
    v_and_b32 v17, 3, v1
    v_lshl_add_u32 v16, v17, 4, v16
    v_add_u32 v16, s44, v16
    v_add_u32 v17, 0x100000, v16
L_nowog:
    s_waitcnt lgkmcnt(0)
    s_barrier
    s_cmp_ge_u32 s28, 4
    s_cbranch_scc1 L_dpub
    ds_read_b128 v[20:23], v4 offset:11264
    s_waitcnt lgkmcnt(0)
    v_mfma_f32_16x16x32_bf16 a[0:3], v[20:23], v[152:155], 0
    v_mfma_f32_16x16x32_bf16 a[4:7], v[20:23], v[156:159], 0
    v_mfma_f32_16x16x32_bf16 a[8:11], v[20:23], v[160:163], 0
    v_mfma_f32_16x16x32_bf16 a[12:15], v[20:23], v[164:167], 0
    v_mfma_f32_16x16x32_bf16 a[16:19], v[20:23], v[168:171], 0
    v_mfma_f32_16x16x32_bf16 a[20:23], v[20:23], v[172:175], 0
    v_mfma_f32_16x16x32_bf16 a[24:27], v[20:23], v[176:179], 0
    v_mfma_f32_16x16x32_bf16 a[28:31], v[20:23], v[180:183], 0
    s_nop 7
    v_accvgpr_read_b32 v152, a0
    v_accvgpr_read_b32 v153, a4
    v_accvgpr_read_b32 v154, a8
    v_accvgpr_read_b32 v155, a12
    v_accvgpr_read_b32 v156, a16
    v_accvgpr_read_b32 v157, a20
    v_accvgpr_read_b32 v158, a24
    v_accvgpr_read_b32 v159, a28
    v_accvgpr_read_b32 v160, a1
    v_accvgpr_read_b32 v161, a5
    v_accvgpr_read_b32 v162, a9
    v_accvgpr_read_b32 v163, a13
    v_accvgpr_read_b32 v164, a17
    v_accvgpr_read_b32 v165, a21
    v_accvgpr_read_b32 v166, a25
    v_accvgpr_read_b32 v167, a29
    v_accvgpr_read_b32 v168, a2
    v_accvgpr_read_b32 v169, a6
    v_accvgpr_read_b32 v170, a10
    v_accvgpr_read_b32 v171, a14
    v_accvgpr_read_b32 v172, a18
    v_accvgpr_read_b32 v173, a22
    v_accvgpr_read_b32 v174, a26
    v_accvgpr_read_b32 v175, a30
    v_accvgpr_read_b32 v176, a3
    v_accvgpr_read_b32 v177, a7
    v_accvgpr_read_b32 v178, a11
    v_accvgpr_read_b32 v179, a15
    v_accvgpr_read_b32 v180, a19
    v_accvgpr_read_b32 v181, a23
    v_accvgpr_read_b32 v182, a27
    v_accvgpr_read_b32 v183, a31
    s_mov_b32 exec_lo, 0xffff
    s_mov_b32 exec_hi, 0
    ds_write_b128 v7, v[152:155] offset:0
    ds_write_b128 v7, v[156:159] offset:16
    ds_write_b128 v7, v[160:163] offset:512
    ds_write_b128 v7, v[164:167] offset:528
    ds_write_b128 v7, v[168:171] offset:1024
    ds_write_b128 v7, v[172:175] offset:1040
    ds_write_b128 v7, v[176:179] offset:1536
    ds_write_b128 v7, v[180:183] offset:1552
    s_mov_b64 exec, -1
    s_waitcnt lgkmcnt(0)
    ds_read_b128 v[8:11], v6
    ds_read_b128 v[12:15], v6 offset:1024
    s_waitcnt lgkmcnt(0)
    v_bfi_b32 v8, v184, s96, v8
    v_bfi_b32 v9, v184, s97, v9
    v_bfi_b32 v10, v184, s98, v10
    v_bfi_b32 v11, v184, s99, v11
    v_bfi_b32 v12, v184, s96, v12
    v_bfi_b32 v13, v184, s97, v13
    v_bfi_b32 v14, v184, s98, v14
    v_bfi_b32 v15, v184, s99, v15
    global_store_dwordx4 v16, v[8:11], s[26:27] sc1
    global_store_dwordx4 v17, v[12:15], s[26:27] sc1
    s_branch L_final
L_dpub:
    s_cmp_ge_u32 s2, 224
    s_cbranch_scc1 L_nodpubA
    s_sub_u32 s58, s28, 4
    s_lshl_b32 s46, s58, 9
    v_lshrrev_b32 v6, 5, v1
    v_lshlrev_b32 v6, 11, v6
    v_and_b32 v7, 31, v1
    v_lshl_add_u32 v6, v7, 4, v6
    v_add_u32 v6, s46, v6
    ds_read_b128 v[12:15], v6 offset:45056
    ds_read_b128 v[16:19], v6 offset:49152
    s_lshl_b32 s44, s58, 18
    s_and_b32 s45, s2, 3
    s_lshl_b32 s45, s45, 16
    s_add_u32 s44, s44, s45
    s_lshr_b32 s45, s2, 2
    s_lshl_b32 s45, s45, 6
    s_add_u32 s44, s44, s45
    s_add_u32 s44, s44, 7340032
    v_lshrrev_b32 v7, 2, v1
    v_lshlrev_b32 v7, 12, v7
    v_and_b32 v5, 3, v1
    v_lshl_add_u32 v7, v5, 4, v7
    v_add_u32 v7, s44, v7
    s_waitcnt lgkmcnt(0)
    v_add_f32 v12, v12, v16
    v_add_f32 v13, v13, v17
    v_add_f32 v14, v14, v18
    v_add_f32 v15, v15, v19
    v_bfi_b32 v12, v184, s96, v12
    v_bfi_b32 v13, v184, s97, v13
    v_bfi_b32 v14, v184, s98, v14
    v_bfi_b32 v15, v184, s99, v15
    global_store_dwordx4 v7, v[12:15], s[26:27] sc1
L_nodpubA:
L_final:
    s_cmp_lg_u32 s28, 0
    s_cbranch_scc1 L_fin2
    s_lshl_b32 s44, s2, 12
    v_lshlrev_b32 v4, 4, v1
    v_add_u32 v4, s44, v4
    v_add_u32 v18, s44, v4
    v_and_b32 v5, 3, v1
    v_lshlrev_b32 v5, 4, v5
    s_lshl_b32 s45, s2, 5
    v_lshrrev_b32 v6, 1, v5
    v_add_u32 v6, s45, v6
    global_load_dwordx2 v[16:17], v6, s[4:5]
    v_mov_b32 v132, s96
    v_mov_b32 v133, s97
    v_mov_b32 v134, s98
    v_mov_b32 v135, s99
    v_add_u32 v4, 7340032, v4
    v_add_u32 v18, 5246976, v18
    s_mov_b32 s62, 0
L_spin_17:
    global_load_dwordx4 v[116:119], v18, s[26:27] offset:3072 sc1
    s_waitcnt vmcnt(0)
    v_xor_b32 v8, s96, v116
    v_xor_b32 v10, s97, v117
    v_or_b32 v8, v8, v10
    v_xor_b32 v10, s98, v118
    v_xor_b32 v11, s99, v119
    v_or3_b32 v8, v8, v10, v11
    v_and_b32 v8, 0xff, v8
    v_cmp_ne_u32 vcc, 0, v8
    s_nop 1
    s_cbranch_vccz L_spun_18
    s_add_u32 s62, s62, 1
    s_cmp_ge_u32 s62, 200000
    s_cbranch_scc1 L_spun_18
    s_sleep 1
    s_branch L_spin_17
L_spun_18:
    s_mov_b32 s62, 0
L_spin_19:
    global_load_dwordx4 v[120:123], v4, s[26:27] offset:0 sc1
    global_load_dwordx4 v[124:127], v4, s[26:27] offset:1024 sc1
    global_load_dwordx4 v[128:131], v4, s[26:27] offset:2048 sc1
    s_mov_b32 exec_hi, 0
    global_load_dwordx4 v[132:135], v4, s[26:27] offset:3072 sc1
    s_mov_b64 exec, -1
    global_load_dwordx4 v[88:91], v18, s[26:27] offset:-4096 sc1
    global_load_dwordx4 v[92:95], v18, s[26:27] offset:-3072 sc1
    global_load_dwordx4 v[96:99], v18, s[26:27] offset:-2048 sc1
    global_load_dwordx4 v[100:103], v18, s[26:27] offset:-1024 sc1
    global_load_dwordx4 v[104:107], v18, s[26:27] offset:0 sc1
    global_load_dwordx4 v[108:111], v18, s[26:27] offset:1024 sc1
    global_load_dwordx4 v[112:115], v18, s[26:27] offset:2048 sc1
    global_load_dwordx4 v[116:119], v18, s[26:27] offset:3072 sc1
    s_waitcnt vmcnt(0)
    v_xor_b32 v8, s96, v88
    v_xor_b32 v10, s97, v89
    v_or_b32 v8, v8, v10
    v_xor_b32 v10, s98, v90
    v_xor_b32 v11, s99, v91
    v_or3_b32 v8, v8, v10, v11
    v_xor_b32 v10, s96, v92
    v_xor_b32 v11, s97, v93
    v_or3_b32 v8, v8, v10, v11
    v_xor_b32 v10, s98, v94
    v_xor_b32 v11, s99, v95
    v_or3_b32 v8, v8, v10, v11
    v_xor_b32 v10, s96, v96
    v_xor_b32 v11, s97, v97
    v_or3_b32 v8, v8, v10, v11
    v_xor_b32 v10, s98, v98
    v_xor_b32 v11, s99, v99
    v_or3_b32 v8, v8, v10, v11
    v_xor_b32 v10, s96, v100
    v_xor_b32 v11, s97, v101
    v_or3_b32 v8, v8, v10, v11
    v_xor_b32 v10, s98, v102
    v_xor_b32 v11, s99, v103
    v_or3_b32 v8, v8, v10, v11
    v_xor_b32 v10, s96, v104
    v_xor_b32 v11, s97, v105
    v_or3_b32 v8, v8, v10, v11
    v_xor_b32 v10, s98, v106
    v_xor_b32 v11, s99, v107
    v_or3_b32 v8, v8, v10, v11
    v_xor_b32 v10, s96, v108
    v_xor_b32 v11, s97, v109
    v_or3_b32 v8, v8, v10, v11
    v_xor_b32 v10, s98, v110
    v_xor_b32 v11, s99, v111
    v_or3_b32 v8, v8, v10, v11
    v_xor_b32 v10, s96, v112
    v_xor_b32 v11, s97, v113
    v_or3_b32 v8, v8, v10, v11
    v_xor_b32 v10, s98, v114
    v_xor_b32 v11, s99, v115
    v_or3_b32 v8, v8, v10, v11
    v_xor_b32 v10, s96, v116
    v_xor_b32 v11, s97, v117
    v_or3_b32 v8, v8, v10, v11
    v_xor_b32 v10, s98, v118
    v_xor_b32 v11, s99, v119
    v_or3_b32 v8, v8, v10, v11
    v_xor_b32 v10, s96, v120
    v_xor_b32 v11, s97, v121
    v_or3_b32 v8, v8, v10, v11
    v_xor_b32 v10, s98, v122
    v_xor_b32 v11, s99, v123
    v_or3_b32 v8, v8, v10, v11
    v_xor_b32 v10, s96, v124
    v_xor_b32 v11, s97, v125
    v_or3_b32 v8, v8, v10, v11
    v_xor_b32 v10, s98, v126
    v_xor_b32 v11, s99, v127
    v_or3_b32 v8, v8, v10, v11
    v_xor_b32 v10, s96, v128
    v_xor_b32 v11, s97, v129
    v_or3_b32 v8, v8, v10, v11
    v_xor_b32 v10, s98, v130
    v_xor_b32 v11, s99, v131
    v_or3_b32 v8, v8, v10, v11
    v_xor_b32 v10, s96, v132
    v_xor_b32 v11, s97, v133
    v_or3_b32 v8, v8, v10, v11
    v_xor_b32 v10, s98, v134
    v_xor_b32 v11, s99, v135
    v_or3_b32 v8, v8, v10, v11
    v_and_b32 v8, 0xff, v8
    v_cmp_ne_u32 vcc, 0, v8
    s_nop 1
    s_cbranch_vccz L_spun_20
    s_add_u32 s62, s62, 1
    s_cmp_ge_u32 s62, 200000
    s_cbranch_scc1 L_spun_20
    s_sleep 1
    s_branch L_spin_19
L_spun_20:
    v_and_b32 v88, 0xffffff00, v88
    v_and_b32 v89, 0xffffff00, v89
    v_and_b32 v90, 0xffffff00, v90
    v_and_b32 v91, 0xffffff00, v91
    v_and_b32 v92, 0xffffff00, v92
    v_and_b32 v93, 0xffffff00, v93
    v_and_b32 v94, 0xffffff00, v94
    v_and_b32 v95, 0xffffff00, v95
    v_and_b32 v96, 0xffffff00, v96
    v_and_b32 v97, 0xffffff00, v97
    v_and_b32 v98, 0xffffff00, v98
    v_and_b32 v99, 0xffffff00, v99
    v_and_b32 v100, 0xffffff00, v100
    v_and_b32 v101, 0xffffff00, v101
    v_and_b32 v102, 0xffffff00, v102
    v_and_b32 v103, 0xffffff00, v103
    v_and_b32 v104, 0xffffff00, v104
    v_and_b32 v105, 0xffffff00, v105
    v_and_b32 v106, 0xffffff00, v106
    v_and_b32 v107, 0xffffff00, v107
    v_and_b32 v108, 0xffffff00, v108
    v_and_b32 v109, 0xffffff00, v109
    v_and_b32 v110, 0xffffff00, v110
    v_and_b32 v111, 0xffffff00, v111
    v_and_b32 v112, 0xffffff00, v112
    v_and_b32 v113, 0xffffff00, v113
    v_and_b32 v114, 0xffffff00, v114
    v_and_b32 v115, 0xffffff00, v115
    v_and_b32 v116, 0xffffff00, v116
    v_and_b32 v117, 0xffffff00, v117
    v_and_b32 v118, 0xffffff00, v118
    v_and_b32 v119, 0xffffff00, v119
    v_and_b32 v120, 0xffffff00, v120
    v_and_b32 v121, 0xffffff00, v121
    v_and_b32 v122, 0xffffff00, v122
    v_and_b32 v123, 0xffffff00, v123
    v_and_b32 v124, 0xffffff00, v124
    v_and_b32 v125, 0xffffff00, v125
    v_and_b32 v126, 0xffffff00, v126
    v_and_b32 v127, 0xffffff00, v127
    v_and_b32 v128, 0xffffff00, v128
    v_and_b32 v129, 0xffffff00, v129
    v_and_b32 v130, 0xffffff00, v130
    v_and_b32 v131, 0xffffff00, v131
    v_and_b32 v132, 0xffffff00, v132
    v_and_b32 v133, 0xffffff00, v133
    v_and_b32 v134, 0xffffff00, v134
    v_and_b32 v135, 0xffffff00, v135
    v_add_f32 v8, v88, v92
    v_add_f32 v12, v120, v124
    v_add_f32 v9, v89, v93
    v_add_f32 v13, v121, v125
    v_add_f32 v10, v90, v94
    v_add_f32 v14, v122, v126
    v_add_f32 v11, v91, v95
    v_add_f32 v15, v123, v127
    v_add_f32 v8, v8, v96
    v_add_f32 v12, v12, v128
    v_add_f32 v9, v9, v97
    v_add_f32 v13, v13, v129
    v_add_f32 v10, v10, v98
    v_add_f32 v14, v14, v130
    v_add_f32 v11, v11, v99
    v_add_f32 v15, v15, v131
    v_add_f32 v8, v8, v100
    v_add_f32 v12, v12, v132
    v_add_f32 v9, v9, v101
    v_add_f32 v13, v13, v133
    v_add_f32 v10, v10, v102
    v_add_f32 v14, v14, v134
    v_add_f32 v11, v11, v103
    v_add_f32 v15, v15, v135
    v_add_f32 v8, v8, v104
    v_add_f32 v9, v9, v105
    v_add_f32 v10, v10, v106
    v_add_f32 v11, v11, v107
    v_add_f32 v8, v8, v108
    v_add_f32 v9, v9, v109
    v_add_f32 v10, v10, v110
    v_add_f32 v11, v11, v111
    v_add_f32 v8, v8, v112
    v_add_f32 v9, v9, v113
    v_add_f32 v10, v10, v114
    v_add_f32 v11, v11, v115
    v_add_f32 v8, v8, v116
    v_add_f32 v9, v9, v117
    v_add_f32 v10, v10, v118
    v_add_f32 v11, v11, v119
    s_nop 1
    v_add_f32_dpp v8, v8, v8 row_ror:8 row_mask:0xf bank_mask:0xf
    v_add_f32_dpp v9, v9, v9 row_ror:8 row_mask:0xf bank_mask:0xf
    v_add_f32_dpp v10, v10, v10 row_ror:8 row_mask:0xf bank_mask:0xf
    v_add_f32_dpp v11, v11, v11 row_ror:8 row_mask:0xf bank_mask:0xf
    v_add_f32_dpp v12, v12, v12 row_ror:8 row_mask:0xf bank_mask:0xf
    v_add_f32_dpp v13, v13, v13 row_ror:8 row_mask:0xf bank_mask:0xf
    v_add_f32_dpp v14, v14, v14 row_ror:8 row_mask:0xf bank_mask:0xf
    v_add_f32_dpp v15, v15, v15 row_ror:8 row_mask:0xf bank_mask:0xf
    s_nop 1
    v_add_f32_dpp v8, v8, v8 row_ror:4 row_mask:0xf bank_mask:0xf
    v_add_f32_dpp v9, v9, v9 row_ror:4 row_mask:0xf bank_mask:0xf
    v_add_f32_dpp v10, v10, v10 row_ror:4 row_mask:0xf bank_mask:0xf
    v_add_f32_dpp v11, v11, v11 row_ror:4 row_mask:0xf bank_mask:0xf
    v_add_f32_dpp v12, v12, v12 row_ror:4 row_mask:0xf bank_mask:0xf
    v_add_f32_dpp v13, v13, v13 row_ror:4 row_mask:0xf bank_mask:0xf
    v_add_f32_dpp v14, v14, v14 row_ror:4 row_mask:0xf bank_mask:0xf
    v_add_f32_dpp v15, v15, v15 row_ror:4 row_mask:0xf bank_mask:0xf
    v_mov_b32 v160, v8
    v_mov_b32 v161, v9
    v_mov_b32 v162, v10
    v_mov_b32 v163, v11
    v_mov_b32 v164, v12
    v_mov_b32 v165, v13
    v_mov_b32 v166, v14
    v_mov_b32 v167, v15
    v_permlane16_swap_b32 v8, v160
    v_permlane16_swap_b32 v9, v161
    v_permlane16_swap_b32 v10, v162
    v_permlane16_swap_b32 v11, v163
    v_permlane16_swap_b32 v12, v164
    v_permlane16_swap_b32 v13, v165
    v_permlane16_swap_b32 v14, v166
    v_permlane16_swap_b32 v15, v167
    v_add_f32 v8, v8, v160
    v_add_f32 v9, v9, v161
    v_add_f32 v10, v10, v162
    v_add_f32 v11, v11, v163
    v_add_f32 v12, v12, v164
    v_add_f32 v13, v13, v165
    v_add_f32 v14, v14, v166
    v_add_f32 v15, v15, v167
    v_mov_b32 v160, v8
    v_mov_b32 v161, v9
    v_mov_b32 v162, v10
    v_mov_b32 v163, v11
    v_mov_b32 v164, v12
    v_mov_b32 v165, v13
    v_mov_b32 v166, v14
    v_mov_b32 v167, v15
    v_permlane32_swap_b32 v8, v160
    v_permlane32_swap_b32 v9, v161
    v_permlane32_swap_b32 v10, v162
    v_permlane32_swap_b32 v11, v163
    v_permlane32_swap_b32 v12, v164
    v_permlane32_swap_b32 v13, v165
    v_permlane32_swap_b32 v14, v166
    v_permlane32_swap_b32 v15, v167
    v_add_f32 v8, v8, v160
    v_add_f32 v9, v9, v161
    v_add_f32 v10, v10, v162
    v_add_f32 v11, v11, v163
    v_add_f32 v12, v12, v164
    v_add_f32 v13, v13, v165
    v_add_f32 v14, v14, v166
    v_add_f32 v15, v15, v167
    s_mov_b32 s44, 0xbfb8aa3b
    v_lshlrev_b32 v152, 16, v16
    v_and_b32 v153, 0xffff0000, v16
    v_lshlrev_b32 v154, 16, v17
    v_and_b32 v155, 0xffff0000, v17
    v_cvt_pk_bf16_f32 v8, v8, v8
    v_and_b32 v8, 0xffff0000, v8
    v_cvt_pk_bf16_f32 v9, v9, v9
    v_and_b32 v9, 0xffff0000, v9
    v_cvt_pk_bf16_f32 v10, v10, v10
    v_and_b32 v10, 0xffff0000, v10
    v_cvt_pk_bf16_f32 v11, v11, v11
    v_and_b32 v11, 0xffff0000, v11
    v_cvt_pk_bf16_f32 v12, v12, v12
    v_and_b32 v12, 0xffff0000, v12
    v_cvt_pk_bf16_f32 v13, v13, v13
    v_and_b32 v13, 0xffff0000, v13
    v_cvt_pk_bf16_f32 v14, v14, v14
    v_and_b32 v14, 0xffff0000, v14
    v_cvt_pk_bf16_f32 v15, v15, v15
    v_and_b32 v15, 0xffff0000, v15
    v_mul_f32 v160, s44, v12
    v_mul_f32 v161, s44, v13
    v_mul_f32 v162, s44, v14
    v_mul_f32 v163, s44, v15
    v_exp_f32 v160, v160
    v_exp_f32 v161, v161
    v_exp_f32 v162, v162
    v_exp_f32 v163, v163
    v_add_f32 v160, 1.0, v160
    v_add_f32 v161, 1.0, v161
    v_add_f32 v162, 1.0, v162
    v_add_f32 v163, 1.0, v163
    v_rcp_f32 v160, v160
    v_rcp_f32 v161, v161
    v_rcp_f32 v162, v162
    v_rcp_f32 v163, v163
    v_mul_f32 v160, v12, v160
    v_mul_f32 v161, v13, v161
    v_mul_f32 v162, v14, v162
    v_mul_f32 v163, v15, v163
    v_cvt_pk_bf16_f32 v160, v160, v160
    v_and_b32 v160, 0xffff0000, v160
    v_cvt_pk_bf16_f32 v161, v161, v161
    v_and_b32 v161, 0xffff0000, v161
    v_cvt_pk_bf16_f32 v162, v162, v162
    v_and_b32 v162, 0xffff0000, v162
    v_cvt_pk_bf16_f32 v163, v163, v163
    v_and_b32 v163, 0xffff0000, v163
    v_mul_f32 v160, v8, v160
    v_mul_f32 v161, v9, v161
    v_mul_f32 v162, v10, v162
    v_mul_f32 v163, v11, v163
    v_cvt_pk_bf16_f32 v160, v160, v160
    v_and_b32 v160, 0xffff0000, v160
    v_cvt_pk_bf16_f32 v161, v161, v161
    v_and_b32 v161, 0xffff0000, v161
    v_cvt_pk_bf16_f32 v162, v162, v162
    v_and_b32 v162, 0xffff0000, v162
    v_cvt_pk_bf16_f32 v163, v163, v163
    v_and_b32 v163, 0xffff0000, v163
    v_add_f32 v152, v152, v160
    v_add_f32 v153, v153, v161
    v_add_f32 v154, v154, v162
    v_add_f32 v155, v155, v163
    v_cvt_pk_bf16_f32 v12, v152, v153
    v_cvt_pk_bf16_f32 v13, v154, v155
    s_mov_b64 exec, 0xf
    global_store_dwordx2 v6, v[12:13], s[22:23]
L_fin2:
L_end:
    s_endpgm
.section .rodata,"a"
.p2align 6
.amdhsa_kernel recurrent_scan__gqa_block_cached__glu_gated_geglu__decode_kernel
  .amdhsa_next_free_vgpr 252
  .amdhsa_next_free_sgpr 102
  .amdhsa_accum_offset 188
  .amdhsa_group_segment_fixed_size 0
  .amdhsa_kernarg_size 96
  .amdhsa_user_sgpr_count 2
  .amdhsa_user_sgpr_kernarg_segment_ptr 1
  .amdhsa_system_sgpr_workgroup_id_x 1
.end_amdhsa_kernel
```
